```python
import torch

def _softmax(x, axis=-1):
    return torch.softmax(x, dim=axis)
def _gelu(x):
    return torch.nn.functional.gelu(x, approximate="tanh")
def _silu(x):
    return torch.nn.functional.silu(x)
def _sigmoid(x):
    return torch.sigmoid(x)
def _layernorm(x, axis=-1, eps=1e-5):
    m = x.mean(dim=axis, keepdim=True)
    v = x.var(dim=axis, keepdim=True, unbiased=False)
    return (x - m) / torch.sqrt(v + eps)
def _scatter_add(tgt, idx, src, axis=0):
    return tgt.clone().index_add_(axis, idx, src)
def _segment_sum(src, seg, n):
    out = torch.zeros((n,) + src.shape[1:], dtype=src.dtype)
    return out.index_add_(0, seg, src)
def _pad(x, pw):
    flat = tuple(v for pair in reversed(pw) for v in pair)
    return torch.nn.functional.pad(x, flat)

kernel_name = 'recurrent_scan__linear_attn_block__geglu_ffn__prompt'

def setup_inputs():

    _w = (lambda a: (lambda t: t.to(torch.bfloat16) if t.is_floating_point() else t)(torch.as_tensor(a)))
    def _A_setup():
        B, S, D = 1, 2048, 512
        return {
            "x": _w((lambda *s: torch.randn(*s, dtype=torch.bfloat16) * 0.05)(B, S, D)),
            "wqkv": _w((lambda *s: torch.randn(*s, dtype=torch.bfloat16) * 0.05)(D, 3 * D)),
            "wo": _w((lambda *s: torch.randn(*s, dtype=torch.bfloat16) * 0.05)(D, D)),
        }
    _A_in = _A_setup()

    def _B_setup():
        B, S, D, F = 1, 2048, 512, 1792
        return {
            "x": _w((lambda *s: torch.randn(*s, dtype=torch.bfloat16) * 0.05)(B, S, D)),
            "w_gate": _w((lambda *s: torch.randn(*s, dtype=torch.bfloat16) * 0.05)(D, F)),
            "w_up": _w((lambda *s: torch.randn(*s, dtype=torch.bfloat16) * 0.05)(D, F)),
            "w_down": _w((lambda *s: torch.randn(*s, dtype=torch.bfloat16) * 0.05)(F, D)),
        }
    _B_in = _B_setup()

    return {
        "A_x": _A_in["x"],
        "A_wqkv": _A_in["wqkv"],
        "A_wo": _A_in["wo"],
        "B_x": _B_in["x"],
        "B_w_gate": _B_in["w_gate"],
        "B_w_up": _B_in["w_up"],
        "B_w_down": _B_in["w_down"],
    }

def reference(A_x, A_wqkv, A_wo, B_x, B_w_gate, B_w_up, B_w_down):
    def _A_ref(x, wqkv, wo):
        B, S, D = x.shape
        H = 32; Dh = D // H
        qkv = (lambda x, *d: x.permute(*d))((x @ wqkv).reshape(B, S, 3, H, Dh), 2, 0, 3, 1, 4)
        q, k, v = qkv[0], qkv[1], qkv[2]
        phi = lambda t: torch.where(t > 0, t + 1, torch.exp(t)) + 1e-6
        pq, pk = phi(q), phi(k)
        kv = torch.einsum("bhsd,bhse->bhde", pk, v)
        z = torch.einsum("bhsd->bhd", pk)
        num = torch.einsum("bhqd,bhde->bhqe", pq, kv)
        den = torch.einsum("bhqd,bhd->bhq", pq, z)[..., None] + 1e-6
        o = num / den
        return (lambda x, *d: x.permute(*d))(o, 0, 2, 1, 3).reshape(B, S, D) @ wo

    def _B_ref(x, w_gate, w_up, w_down):
        return (_gelu(x @ w_gate) * (x @ w_up)) @ w_down

    x = A_x
    xn = _layernorm(x, axis=-1)
    s = _A_ref(xn, A_wqkv, A_wo)
    g = _silu(_B_ref(xn, B_w_gate, B_w_up, B_w_down))
    return x + s * g
```

```asm
; @launch kernel=ln_kernel grid=(744,1,1) block=(256,1,1) lds=0
; @launch kernel=k1_kernel grid=(256,1,1) block=(512,1,1) lds=132096
; @launch kernel=k2_kernel grid=(256,1,1) block=(256,1,1) lds=98304
.amdgcn_target "amdgcn-amd-amdhsa--gfx950"
.text
.globl ln_kernel
.p2align 8
.type ln_kernel,@function
ln_kernel:
    s_cmp_ge_u32 s2, 512
    s_cbranch_scc1 L_ln_pref
    s_load_dwordx2 s[4:5], s[0:1], 0
    s_load_dwordx2 s[6:7], s[0:1], 72
    v_and_b32 v1, 63, v0
    v_lshrrev_b32 v2, 6, v0
    s_lshl_b32 s3, s2, 2
    v_add_u32 v2, s3, v2
    v_lshlrev_b32 v3, 10, v2
    v_lshlrev_b32 v4, 4, v1
    v_add_u32 v3, v3, v4
    s_waitcnt lgkmcnt(0)
    s_mov_b32 s8, s4
    s_mov_b32 s9, s5
    s_mov_b32 s10, 2097152
    s_mov_b32 s11, 0x00020000
    s_mov_b32 s12, s6
    s_mov_b32 s13, s7
    s_mov_b32 s14, 268435456
    s_mov_b32 s15, 0x00020000
    buffer_load_dwordx4 v[8:11], v3, s[8:11], 0 offen
    s_cmp_ge_u32 s2, 64
    s_cbranch_scc1 L_ln_nozero
    v_lshlrev_b32 v5, 2, v0
    s_lshl_b32 s3, s2, 10
    s_add_u32 s3, s3, 11534336
    v_mov_b32 v6, 0
    buffer_store_dword v6, v5, s[12:15], s3 offen
L_ln_nozero:
    v_lshrrev_b32 v5, 5, v2
    v_lshlrev_b32 v5, 5, v5
    v_lshrrev_b32 v6, 1, v1
    v_add_u32 v5, v5, v6
    v_lshlrev_b32 v5, 10, v5
    v_and_b32 v6, 1, v1
    v_lshlrev_b32 v6, 5, v6
    v_and_b32 v7, 31, v2
    v_add_u32 v6, v6, v7
    v_lshlrev_b32 v6, 4, v6
    v_add_u32 v5, v5, v6
    s_waitcnt vmcnt(0)
    v_lshlrev_b32 v16, 16, v8
    v_and_b32 v17, 0xffff0000, v8
    v_lshlrev_b32 v18, 16, v9
    v_and_b32 v19, 0xffff0000, v9
    v_lshlrev_b32 v20, 16, v10
    v_and_b32 v21, 0xffff0000, v10
    v_lshlrev_b32 v22, 16, v11
    v_and_b32 v23, 0xffff0000, v11
    v_add_f32 v24, v16, v17
    v_add_f32 v25, v18, v19
    v_add_f32 v26, v20, v21
    v_add_f32 v27, v22, v23
    v_add_f32 v24, v24, v25
    v_add_f32 v26, v26, v27
    v_add_f32 v24, v24, v26
    s_nop 1
    v_add_f32_dpp v25, v24, v24 quad_perm:[1,0,3,2] row_mask:0xf bank_mask:0xf
    s_nop 1
    v_add_f32_dpp v24, v25, v25 quad_perm:[2,3,0,1] row_mask:0xf bank_mask:0xf
    s_nop 1
    v_add_f32_dpp v25, v24, v24 row_ror:4 row_mask:0xf bank_mask:0xf
    s_nop 1
    v_add_f32_dpp v24, v25, v25 row_ror:8 row_mask:0xf bank_mask:0xf
    s_nop 0
    v_readlane_b32 s16, v24, 0
    v_readlane_b32 s17, v24, 16
    v_readlane_b32 s18, v24, 32
    v_readlane_b32 s19, v24, 48
    v_mov_b32 v24, s16
    v_add_f32 v24, s17, v24
    v_add_f32 v24, s18, v24
    v_add_f32 v24, s19, v24
    v_mul_f32 v24, 0x3b000000, v24
    v_mov_b32 v26, 0
    v_sub_f32 v27, v16, v24
    v_fmac_f32 v26, v27, v27
    v_sub_f32 v27, v17, v24
    v_fmac_f32 v26, v27, v27
    v_sub_f32 v27, v18, v24
    v_fmac_f32 v26, v27, v27
    v_sub_f32 v27, v19, v24
    v_fmac_f32 v26, v27, v27
    v_sub_f32 v27, v20, v24
    v_fmac_f32 v26, v27, v27
    v_sub_f32 v27, v21, v24
    v_fmac_f32 v26, v27, v27
    v_sub_f32 v27, v22, v24
    v_fmac_f32 v26, v27, v27
    v_sub_f32 v27, v23, v24
    v_fmac_f32 v26, v27, v27
    s_nop 1
    v_add_f32_dpp v25, v26, v26 quad_perm:[1,0,3,2] row_mask:0xf bank_mask:0xf
    s_nop 1
    v_add_f32_dpp v26, v25, v25 quad_perm:[2,3,0,1] row_mask:0xf bank_mask:0xf
    s_nop 1
    v_add_f32_dpp v25, v26, v26 row_ror:4 row_mask:0xf bank_mask:0xf
    s_nop 1
    v_add_f32_dpp v26, v25, v25 row_ror:8 row_mask:0xf bank_mask:0xf
    s_nop 0
    v_readlane_b32 s16, v26, 0
    v_readlane_b32 s17, v26, 16
    v_readlane_b32 s18, v26, 32
    v_readlane_b32 s19, v26, 48
    v_mov_b32 v26, s16
    v_add_f32 v26, s17, v26
    v_add_f32 v26, s18, v26
    v_add_f32 v26, s19, v26
    v_mul_f32 v26, 0x3b000000, v26
    v_cvt_pk_bf16_f32 v25, v24, v24
    v_lshlrev_b32 v28, 16, v25
    v_cvt_pk_bf16_f32 v25, v26, v26
    v_lshlrev_b32 v29, 16, v25
    v_add_f32 v29, 0x3727c5ac, v29
    v_cvt_pk_bf16_f32 v25, v29, v29
    v_lshlrev_b32 v29, 16, v25
    v_sqrt_f32 v29, v29
    s_nop 0
    v_cvt_pk_bf16_f32 v25, v29, v29
    v_lshlrev_b32 v29, 16, v25
    v_rcp_f32 v30, v29
    s_nop 0
    v_fma_f32 v31, -v29, v30, 1.0
    v_fma_f32 v30, v31, v30, v30
    v_sub_f32 v16, v16, v28
    v_sub_f32 v17, v17, v28
    v_cvt_pk_bf16_f32 v32, v16, v17
    v_lshlrev_b32 v16, 16, v32
    v_and_b32 v17, 0xffff0000, v32
    v_mul_f32 v33, v16, v30
    v_mul_f32 v34, v17, v30
    v_fma_f32 v35, -v33, v29, v16
    v_fma_f32 v36, -v34, v29, v17
    v_fma_f32 v33, v35, v30, v33
    v_fma_f32 v34, v36, v30, v34
    v_cvt_pk_bf16_f32 v12, v33, v34
    v_sub_f32 v18, v18, v28
    v_sub_f32 v19, v19, v28
    v_cvt_pk_bf16_f32 v32, v18, v19
    v_lshlrev_b32 v18, 16, v32
    v_and_b32 v19, 0xffff0000, v32
    v_mul_f32 v33, v18, v30
    v_mul_f32 v34, v19, v30
    v_fma_f32 v35, -v33, v29, v18
    v_fma_f32 v36, -v34, v29, v19
    v_fma_f32 v33, v35, v30, v33
    v_fma_f32 v34, v36, v30, v34
    v_cvt_pk_bf16_f32 v13, v33, v34
    v_sub_f32 v20, v20, v28
    v_sub_f32 v21, v21, v28
    v_cvt_pk_bf16_f32 v32, v20, v21
    v_lshlrev_b32 v20, 16, v32
    v_and_b32 v21, 0xffff0000, v32
    v_mul_f32 v33, v20, v30
    v_mul_f32 v34, v21, v30
    v_fma_f32 v35, -v33, v29, v20
    v_fma_f32 v36, -v34, v29, v21
    v_fma_f32 v33, v35, v30, v33
    v_fma_f32 v34, v36, v30, v34
    v_cvt_pk_bf16_f32 v14, v33, v34
    v_sub_f32 v22, v22, v28
    v_sub_f32 v23, v23, v28
    v_cvt_pk_bf16_f32 v32, v22, v23
    v_lshlrev_b32 v22, 16, v32
    v_and_b32 v23, 0xffff0000, v32
    v_mul_f32 v33, v22, v30
    v_mul_f32 v34, v23, v30
    v_fma_f32 v35, -v33, v29, v22
    v_fma_f32 v36, -v34, v29, v23
    v_fma_f32 v33, v35, v30, v33
    v_fma_f32 v34, v36, v30, v34
    v_cvt_pk_bf16_f32 v15, v33, v34
    buffer_store_dwordx4 v[12:15], v5, s[12:15], 0 offen
    s_endpgm
L_ln_pref:
    s_sub_u32 s3, s2, 512
    s_cmp_ge_u32 s3, 232
    s_cbranch_scc1 L_ln_end
    s_load_dwordx2 s[4:5], s[0:1], 8
    s_load_dwordx2 s[6:7], s[0:1], 16
    s_load_dwordx2 s[8:9], s[0:1], 32
    s_load_dwordx2 s[10:11], s[0:1], 40
    s_load_dwordx2 s[12:13], s[0:1], 48
    v_lshlrev_b32 v1, 4, v0
    s_waitcnt lgkmcnt(0)
    s_mov_b32 s16, s4
    s_mov_b32 s17, s5
    s_mov_b32 s18, 1572864
    s_cmp_lt_u32 s3, 48
    s_cbranch_scc1 L_ln_pf_go
    s_sub_u32 s3, s3, 48
    s_mov_b32 s16, s6
    s_mov_b32 s17, s7
    s_mov_b32 s18, 524288
    s_cmp_lt_u32 s3, 16
    s_cbranch_scc1 L_ln_pf_go
    s_sub_u32 s3, s3, 16
    s_mov_b32 s16, s8
    s_mov_b32 s17, s9
    s_mov_b32 s18, 1835008
    s_cmp_lt_u32 s3, 56
    s_cbranch_scc1 L_ln_pf_go
    s_sub_u32 s3, s3, 56
    s_mov_b32 s16, s10
    s_mov_b32 s17, s11
    s_cmp_lt_u32 s3, 56
    s_cbranch_scc1 L_ln_pf_go
    s_sub_u32 s3, s3, 56
    s_mov_b32 s16, s12
    s_mov_b32 s17, s13
L_ln_pf_go:
    s_mov_b32 s19, 0x00020000
    s_lshl_b32 s3, s3, 15
    buffer_load_dwordx4 v[8:11], v1, s[16:19], s3 offen
    s_add_u32 s3, s3, 4096
    buffer_load_dwordx4 v[12:15], v1, s[16:19], s3 offen
    s_add_u32 s3, s3, 4096
    buffer_load_dwordx4 v[16:19], v1, s[16:19], s3 offen
    s_add_u32 s3, s3, 4096
    buffer_load_dwordx4 v[20:23], v1, s[16:19], s3 offen
    s_add_u32 s3, s3, 4096
    buffer_load_dwordx4 v[24:27], v1, s[16:19], s3 offen
    s_add_u32 s3, s3, 4096
    buffer_load_dwordx4 v[28:31], v1, s[16:19], s3 offen
    s_add_u32 s3, s3, 4096
    buffer_load_dwordx4 v[32:35], v1, s[16:19], s3 offen
    s_add_u32 s3, s3, 4096
    buffer_load_dwordx4 v[36:39], v1, s[16:19], s3 offen
    s_add_u32 s3, s3, 4096
    s_waitcnt vmcnt(0)
L_ln_end:
    s_endpgm
.globl k1_kernel
.p2align 8
.type k1_kernel,@function
k1_kernel:
    s_cmp_ge_u32 s2, 256
    s_cbranch_scc1 L_k1_end
    s_load_dwordx2 s[4:5], s[0:1], 8
    s_load_dwordx2 s[6:7], s[0:1], 32
    s_load_dwordx2 s[8:9], s[0:1], 40
    s_load_dwordx2 s[10:11], s[0:1], 72
    v_lshrrev_b32 v1, 6, v0
    v_and_b32 v2, 63, v0
    s_and_b32 s12, s2, 7
    s_lshr_b32 s13, s2, 3
    s_lshl_b32 s14, s12, 2
    s_and_b32 s15, s13, 3
    s_add_u32 s14, s14, s15
    s_lshr_b32 s15, s13, 2
    v_readfirstlane_b32 s16, v1
    s_mov_b32 s40, 0xc0135761
    s_mov_b32 s41, 0xc0135761
    s_mov_b32 s42, 0xbdd2d3e8
    s_mov_b32 s43, 0xbdd2d3e8
    s_mov_b32 s44, 1.0
    s_mov_b32 s45, 1.0
    s_mov_b32 s46, 0x3fb8aa3b
    s_mov_b32 s47, 0x3fb8aa3b
    s_mov_b32 s48, 0x358637bd
    s_mov_b32 s49, 0x358637bd
    s_mov_b32 s50, 0xffff0000
    s_mov_b32 s51, 0xffff0000
    s_waitcnt lgkmcnt(0)
    s_mov_b32 s20, s10
    s_mov_b32 s21, s11
    s_mov_b32 s22, 268435456
    s_mov_b32 s23, 0x00020000
    s_mov_b32 s32, s4
    s_mov_b32 s33, s5
    s_mov_b32 s34, 1572864
    s_mov_b32 s35, 0x00020000
    s_and_b32 s17, s16, 1
    s_lshr_b32 s18, s16, 1
    s_cmp_ge_u32 s14, 28
    s_cbranch_scc1 L_k1_qsrc
    s_cmp_eq_u32 s17, 0
    s_cselect_b32 s24, s6, s8
    s_cselect_b32 s25, s7, s9
    s_lshl_b32 s19, s14, 7
    s_mov_b32 s28, 3584
    s_mov_b32 s29, 1835008
    s_branch L_k1_srcdone
L_k1_qsrc:
    s_mov_b32 s24, s4
    s_mov_b32 s25, s5
    s_sub_u32 s19, s14, 28
    s_lshl_b32 s19, s19, 8
    s_lshl_b32 s30, s17, 7
    s_add_u32 s19, s19, s30
    s_mov_b32 s28, 3072
    s_mov_b32 s29, 1572864
L_k1_srcdone:
    s_add_u32 s24, s24, s19
    s_addc_u32 s25, s25, 0
    s_sub_u32 s26, s29, s19
    s_mov_b32 s27, 0x00020000
    v_lshrrev_b32 v3, 3, v2
    v_mul_lo_u32 v3, v3, s28
    v_bfe_u32 v4, v2, 1, 2
    v_bfe_u32 v5, v2, 4, 1
    v_xor_b32 v4, v4, v5
    v_lshlrev_b32 v4, 5, v4
    v_and_b32 v5, 1, v2
    v_lshlrev_b32 v5, 4, v5
    v_add3_u32 v3, v3, v4, v5
    v_lshrrev_b32 v4, 2, v2
    v_mul_u32_u24 v4, 3072, v4
    v_bfe_u32 v5, v2, 1, 1
    v_lshlrev_b32 v5, 10, v5
    v_sub_u32 v5, 2048, v5
    v_add_u32 v4, v4, v5
    v_and_b32 v5, 1, v2
    v_lshlrev_b32 v5, 4, v5
    s_lshl_b32 s30, s14, 5
    v_add3_u32 v4, v4, v5, s30
    v_bfe_u32 v5, v2, 4, 1
    v_mul_u32_u24 v5, 8256, v5
    v_lshrrev_b32 v6, 5, v2
    v_lshlrev_b32 v6, 3, v6
    v_bfe_u32 v7, v2, 2, 2
    v_add_u32 v6, v6, v7
    v_lshlrev_b32 v6, 7, v6
    v_add_u32 v5, v5, v6
    v_and_b32 v6, 3, v2
    v_lshlrev_b32 v6, 3, v6
    v_add_u32 v5, v5, v6
    v_bfe_u32 v7, v2, 3, 1
    v_xor_b32 v6, 0, v7
    v_lshlrev_b32 v6, 5, v6
    v_add_u32 v8, v5, v6
    v_add_u32 v12, 66048, v8
    v_xor_b32 v6, 1, v7
    v_lshlrev_b32 v6, 5, v6
    v_add_u32 v9, v5, v6
    v_add_u32 v13, 66048, v9
    v_xor_b32 v6, 2, v7
    v_lshlrev_b32 v6, 5, v6
    v_add_u32 v10, v5, v6
    v_add_u32 v14, 66048, v10
    v_xor_b32 v6, 3, v7
    v_lshlrev_b32 v6, 5, v6
    v_add_u32 v11, v5, v6
    v_add_u32 v15, 66048, v11
    v_lshrrev_b32 v6, 5, v2
    v_lshlrev_b32 v6, 3, v6
    v_bfe_u32 v7, v2, 2, 2
    v_add_u32 v6, v6, v7
    v_lshlrev_b32 v6, 6, v6
    v_bfe_u32 v7, v2, 4, 1
    v_lshlrev_b32 v7, 5, v7
    v_add_u32 v6, v6, v7
    v_and_b32 v7, 3, v2
    v_lshlrev_b32 v7, 3, v7
    v_add_u32 v6, v6, v7
    v_lshlrev_b32 v7, 4, v2
    s_lshl_b32 s31, s15, 3
    s_add_u32 s31, s31, s16
    s_lshl_b32 s36, s31, 15
    s_mul_i32 s37, s17, 8256
    s_lshl_b32 s30, s18, 11
    s_add_u32 s37, s37, s30
    s_lshl_b32 s30, s18, 4
    s_mul_i32 s38, s30, s28
    s_lshl_b32 s39, s28, 3
    s_add_u32 m0, s37, 0
    s_mul_i32 s30, s28, 0
    s_add_u32 s30, s30, s38
    buffer_load_dwordx4 v3, s[24:27], s30 offen lds
    s_add_u32 m0, s37, 1024
    s_add_u32 s30, s30, s39
    buffer_load_dwordx4 v3, s[24:27], s30 offen lds
    s_add_u32 s30, s36, 0
    buffer_load_dwordx4 a[0:3], v7, s[20:23], s30 offen offset:0
    buffer_load_dwordx4 a[4:7], v7, s[20:23], s30 offen offset:1024
    buffer_load_dwordx4 a[8:11], v7, s[20:23], s30 offen offset:2048
    buffer_load_dwordx4 a[12:15], v7, s[20:23], s30 offen offset:3072
    s_add_u32 m0, s37, 16512
    s_mul_i32 s30, s28, 64
    s_add_u32 s30, s30, s38
    buffer_load_dwordx4 v3, s[24:27], s30 offen lds
    s_add_u32 m0, s37, 17536
    s_add_u32 s30, s30, s39
    buffer_load_dwordx4 v3, s[24:27], s30 offen lds
    s_add_u32 s30, s36, 4096
    buffer_load_dwordx4 a[16:19], v7, s[20:23], s30 offen offset:0
    buffer_load_dwordx4 a[20:23], v7, s[20:23], s30 offen offset:1024
    buffer_load_dwordx4 a[24:27], v7, s[20:23], s30 offen offset:2048
    buffer_load_dwordx4 a[28:31], v7, s[20:23], s30 offen offset:3072
    s_add_u32 m0, s37, 33024
    s_mul_i32 s30, s28, 128
    s_add_u32 s30, s30, s38
    buffer_load_dwordx4 v3, s[24:27], s30 offen lds
    s_add_u32 m0, s37, 34048
    s_add_u32 s30, s30, s39
    buffer_load_dwordx4 v3, s[24:27], s30 offen lds
    s_add_u32 s30, s36, 8192
    buffer_load_dwordx4 a[32:35], v7, s[20:23], s30 offen offset:0
    buffer_load_dwordx4 a[36:39], v7, s[20:23], s30 offen offset:1024
    buffer_load_dwordx4 a[40:43], v7, s[20:23], s30 offen offset:2048
    buffer_load_dwordx4 a[44:47], v7, s[20:23], s30 offen offset:3072
    s_add_u32 m0, s37, 49536
    s_mul_i32 s30, s28, 192
    s_add_u32 s30, s30, s38
    buffer_load_dwordx4 v3, s[24:27], s30 offen lds
    s_add_u32 m0, s37, 50560
    s_add_u32 s30, s30, s39
    buffer_load_dwordx4 v3, s[24:27], s30 offen lds
    s_add_u32 s30, s36, 12288
    buffer_load_dwordx4 a[48:51], v7, s[20:23], s30 offen offset:0
    buffer_load_dwordx4 a[52:55], v7, s[20:23], s30 offen offset:1024
    buffer_load_dwordx4 a[56:59], v7, s[20:23], s30 offen offset:2048
    buffer_load_dwordx4 a[60:63], v7, s[20:23], s30 offen offset:3072
    s_add_u32 m0, s37, 66048
    s_mul_i32 s30, s28, 256
    s_add_u32 s30, s30, s38
    buffer_load_dwordx4 v3, s[24:27], s30 offen lds
    s_add_u32 m0, s37, 67072
    s_add_u32 s30, s30, s39
    buffer_load_dwordx4 v3, s[24:27], s30 offen lds
    s_add_u32 s30, s36, 16384
    buffer_load_dwordx4 a[64:67], v7, s[20:23], s30 offen offset:0
    buffer_load_dwordx4 a[68:71], v7, s[20:23], s30 offen offset:1024
    buffer_load_dwordx4 a[72:75], v7, s[20:23], s30 offen offset:2048
    buffer_load_dwordx4 a[76:79], v7, s[20:23], s30 offen offset:3072
    s_add_u32 m0, s37, 82560
    s_mul_i32 s30, s28, 320
    s_add_u32 s30, s30, s38
    buffer_load_dwordx4 v3, s[24:27], s30 offen lds
    s_add_u32 m0, s37, 83584
    s_add_u32 s30, s30, s39
    buffer_load_dwordx4 v3, s[24:27], s30 offen lds
    s_add_u32 s30, s36, 20480
    buffer_load_dwordx4 a[80:83], v7, s[20:23], s30 offen offset:0
    buffer_load_dwordx4 a[84:87], v7, s[20:23], s30 offen offset:1024
    buffer_load_dwordx4 a[88:91], v7, s[20:23], s30 offen offset:2048
    buffer_load_dwordx4 a[92:95], v7, s[20:23], s30 offen offset:3072
    s_add_u32 m0, s37, 99072
    s_mul_i32 s30, s28, 384
    s_add_u32 s30, s30, s38
    buffer_load_dwordx4 v3, s[24:27], s30 offen lds
    s_add_u32 m0, s37, 100096
    s_add_u32 s30, s30, s39
    buffer_load_dwordx4 v3, s[24:27], s30 offen lds
    s_add_u32 s30, s36, 24576
    buffer_load_dwordx4 a[96:99], v7, s[20:23], s30 offen offset:0
    buffer_load_dwordx4 a[100:103], v7, s[20:23], s30 offen offset:1024
    buffer_load_dwordx4 a[104:107], v7, s[20:23], s30 offen offset:2048
    buffer_load_dwordx4 a[108:111], v7, s[20:23], s30 offen offset:3072
    s_add_u32 m0, s37, 115584
    s_mul_i32 s30, s28, 448
    s_add_u32 s30, s30, s38
    buffer_load_dwordx4 v3, s[24:27], s30 offen lds
    s_add_u32 m0, s37, 116608
    s_add_u32 s30, s30, s39
    buffer_load_dwordx4 v3, s[24:27], s30 offen lds
    s_add_u32 s30, s36, 28672
    buffer_load_dwordx4 a[112:115], v7, s[20:23], s30 offen offset:0
    buffer_load_dwordx4 a[116:119], v7, s[20:23], s30 offen offset:1024
    buffer_load_dwordx4 a[120:123], v7, s[20:23], s30 offen offset:2048
    buffer_load_dwordx4 a[124:127], v7, s[20:23], s30 offen offset:3072
    s_waitcnt vmcnt(40)
    s_barrier
    ds_read_b64_tr_b16 v[16:17], v8 offset:0
    ds_read_b64_tr_b16 v[18:19], v8 offset:512
    ds_read_b64_tr_b16 v[20:21], v9 offset:0
    ds_read_b64_tr_b16 v[22:23], v9 offset:512
    ds_read_b64_tr_b16 v[24:25], v8 offset:2048
    ds_read_b64_tr_b16 v[26:27], v8 offset:2560
    s_waitcnt lgkmcnt(4)
    v_mfma_f32_32x32x16_bf16 v[32:47], v[16:19], a[0:3], 0
    ds_read_b64_tr_b16 v[28:29], v9 offset:2048
    ds_read_b64_tr_b16 v[30:31], v9 offset:2560
    s_waitcnt lgkmcnt(4)
    v_mfma_f32_32x32x16_bf16 v[48:63], v[20:23], a[0:3], 0
    ds_read_b64_tr_b16 v[16:17], v8 offset:4096
    ds_read_b64_tr_b16 v[18:19], v8 offset:4608
    s_waitcnt lgkmcnt(4)
    v_mfma_f32_32x32x16_bf16 v[32:47], v[24:27], a[4:7], v[32:47]
    ds_read_b64_tr_b16 v[20:21], v9 offset:4096
    ds_read_b64_tr_b16 v[22:23], v9 offset:4608
    s_waitcnt lgkmcnt(4)
    v_mfma_f32_32x32x16_bf16 v[48:63], v[28:31], a[4:7], v[48:63]
    ds_read_b64_tr_b16 v[24:25], v8 offset:6144
    ds_read_b64_tr_b16 v[26:27], v8 offset:6656
    s_waitcnt lgkmcnt(4)
    v_mfma_f32_32x32x16_bf16 v[32:47], v[16:19], a[8:11], v[32:47]
    ds_read_b64_tr_b16 v[28:29], v9 offset:6144
    ds_read_b64_tr_b16 v[30:31], v9 offset:6656
    s_waitcnt lgkmcnt(4)
    v_mfma_f32_32x32x16_bf16 v[48:63], v[20:23], a[8:11], v[48:63]
    ds_read_b64_tr_b16 v[16:17], v8 offset:16512
    ds_read_b64_tr_b16 v[18:19], v8 offset:17024
    s_waitcnt lgkmcnt(4)
    v_mfma_f32_32x32x16_bf16 v[32:47], v[24:27], a[12:15], v[32:47]
    ds_read_b64_tr_b16 v[20:21], v9 offset:16512
    ds_read_b64_tr_b16 v[22:23], v9 offset:17024
    s_waitcnt lgkmcnt(4)
    v_mfma_f32_32x32x16_bf16 v[48:63], v[28:31], a[12:15], v[48:63]
    ds_read_b64_tr_b16 v[24:25], v8 offset:18560
    ds_read_b64_tr_b16 v[26:27], v8 offset:19072
    s_waitcnt vmcnt(34)
    s_barrier
    s_waitcnt lgkmcnt(4)
    v_mfma_f32_32x32x16_bf16 v[32:47], v[16:19], a[16:19], v[32:47]
    ds_read_b64_tr_b16 v[28:29], v9 offset:18560
    ds_read_b64_tr_b16 v[30:31], v9 offset:19072
    s_waitcnt lgkmcnt(4)
    v_mfma_f32_32x32x16_bf16 v[48:63], v[20:23], a[16:19], v[48:63]
    ds_read_b64_tr_b16 v[16:17], v8 offset:20608
    ds_read_b64_tr_b16 v[18:19], v8 offset:21120
    s_waitcnt lgkmcnt(4)
    v_mfma_f32_32x32x16_bf16 v[32:47], v[24:27], a[20:23], v[32:47]
    ds_read_b64_tr_b16 v[20:21], v9 offset:20608
    ds_read_b64_tr_b16 v[22:23], v9 offset:21120
    s_waitcnt lgkmcnt(4)
    v_mfma_f32_32x32x16_bf16 v[48:63], v[28:31], a[20:23], v[48:63]
    ds_read_b64_tr_b16 v[24:25], v8 offset:22656
    ds_read_b64_tr_b16 v[26:27], v8 offset:23168
    s_waitcnt lgkmcnt(4)
    v_mfma_f32_32x32x16_bf16 v[32:47], v[16:19], a[24:27], v[32:47]
    ds_read_b64_tr_b16 v[28:29], v9 offset:22656
    ds_read_b64_tr_b16 v[30:31], v9 offset:23168
    s_waitcnt lgkmcnt(4)
    v_mfma_f32_32x32x16_bf16 v[48:63], v[20:23], a[24:27], v[48:63]
    ds_read_b64_tr_b16 v[16:17], v8 offset:33024
    ds_read_b64_tr_b16 v[18:19], v8 offset:33536
    s_waitcnt lgkmcnt(4)
    v_mfma_f32_32x32x16_bf16 v[32:47], v[24:27], a[28:31], v[32:47]
    ds_read_b64_tr_b16 v[20:21], v9 offset:33024
    ds_read_b64_tr_b16 v[22:23], v9 offset:33536
    s_waitcnt lgkmcnt(4)
    v_mfma_f32_32x32x16_bf16 v[48:63], v[28:31], a[28:31], v[48:63]
    ds_read_b64_tr_b16 v[24:25], v8 offset:35072
    ds_read_b64_tr_b16 v[26:27], v8 offset:35584
    s_waitcnt vmcnt(28)
    s_barrier
    s_waitcnt lgkmcnt(4)
    v_mfma_f32_32x32x16_bf16 v[32:47], v[16:19], a[32:35], v[32:47]
    ds_read_b64_tr_b16 v[28:29], v9 offset:35072
    ds_read_b64_tr_b16 v[30:31], v9 offset:35584
    s_waitcnt lgkmcnt(4)
    v_mfma_f32_32x32x16_bf16 v[48:63], v[20:23], a[32:35], v[48:63]
    ds_read_b64_tr_b16 v[16:17], v8 offset:37120
    ds_read_b64_tr_b16 v[18:19], v8 offset:37632
    s_waitcnt lgkmcnt(4)
    v_mfma_f32_32x32x16_bf16 v[32:47], v[24:27], a[36:39], v[32:47]
    ds_read_b64_tr_b16 v[20:21], v9 offset:37120
    ds_read_b64_tr_b16 v[22:23], v9 offset:37632
    s_waitcnt lgkmcnt(4)
    v_mfma_f32_32x32x16_bf16 v[48:63], v[28:31], a[36:39], v[48:63]
    ds_read_b64_tr_b16 v[24:25], v8 offset:39168
    ds_read_b64_tr_b16 v[26:27], v8 offset:39680
    s_waitcnt lgkmcnt(4)
    v_mfma_f32_32x32x16_bf16 v[32:47], v[16:19], a[40:43], v[32:47]
    ds_read_b64_tr_b16 v[28:29], v9 offset:39168
    ds_read_b64_tr_b16 v[30:31], v9 offset:39680
    s_waitcnt lgkmcnt(4)
    v_mfma_f32_32x32x16_bf16 v[48:63], v[20:23], a[40:43], v[48:63]
    ds_read_b64_tr_b16 v[16:17], v8 offset:49536
    ds_read_b64_tr_b16 v[18:19], v8 offset:50048
    s_waitcnt lgkmcnt(4)
    v_mfma_f32_32x32x16_bf16 v[32:47], v[24:27], a[44:47], v[32:47]
    ds_read_b64_tr_b16 v[20:21], v9 offset:49536
    ds_read_b64_tr_b16 v[22:23], v9 offset:50048
    s_waitcnt lgkmcnt(4)
    v_mfma_f32_32x32x16_bf16 v[48:63], v[28:31], a[44:47], v[48:63]
    ds_read_b64_tr_b16 v[24:25], v8 offset:51584
    ds_read_b64_tr_b16 v[26:27], v8 offset:52096
    s_waitcnt vmcnt(22)
    s_barrier
    s_waitcnt lgkmcnt(4)
    v_mfma_f32_32x32x16_bf16 v[32:47], v[16:19], a[48:51], v[32:47]
    ds_read_b64_tr_b16 v[28:29], v9 offset:51584
    ds_read_b64_tr_b16 v[30:31], v9 offset:52096
    s_waitcnt lgkmcnt(4)
    v_mfma_f32_32x32x16_bf16 v[48:63], v[20:23], a[48:51], v[48:63]
    ds_read_b64_tr_b16 v[16:17], v8 offset:53632
    ds_read_b64_tr_b16 v[18:19], v8 offset:54144
    s_waitcnt lgkmcnt(4)
    v_mfma_f32_32x32x16_bf16 v[32:47], v[24:27], a[52:55], v[32:47]
    ds_read_b64_tr_b16 v[20:21], v9 offset:53632
    ds_read_b64_tr_b16 v[22:23], v9 offset:54144
    s_waitcnt lgkmcnt(4)
    v_mfma_f32_32x32x16_bf16 v[48:63], v[28:31], a[52:55], v[48:63]
    ds_read_b64_tr_b16 v[24:25], v8 offset:55680
    ds_read_b64_tr_b16 v[26:27], v8 offset:56192
    s_waitcnt lgkmcnt(4)
    v_mfma_f32_32x32x16_bf16 v[32:47], v[16:19], a[56:59], v[32:47]
    ds_read_b64_tr_b16 v[28:29], v9 offset:55680
    ds_read_b64_tr_b16 v[30:31], v9 offset:56192
    s_waitcnt lgkmcnt(4)
    v_mfma_f32_32x32x16_bf16 v[48:63], v[20:23], a[56:59], v[48:63]
    ds_read_b64_tr_b16 v[16:17], v12 offset:0
    ds_read_b64_tr_b16 v[18:19], v12 offset:512
    s_waitcnt lgkmcnt(4)
    v_mfma_f32_32x32x16_bf16 v[32:47], v[24:27], a[60:63], v[32:47]
    ds_read_b64_tr_b16 v[20:21], v13 offset:0
    ds_read_b64_tr_b16 v[22:23], v13 offset:512
    s_waitcnt lgkmcnt(4)
    v_mfma_f32_32x32x16_bf16 v[48:63], v[28:31], a[60:63], v[48:63]
    ds_read_b64_tr_b16 v[24:25], v12 offset:2048
    ds_read_b64_tr_b16 v[26:27], v12 offset:2560
    s_waitcnt vmcnt(16)
    s_barrier
    s_waitcnt lgkmcnt(4)
    v_mfma_f32_32x32x16_bf16 v[32:47], v[16:19], a[64:67], v[32:47]
    ds_read_b64_tr_b16 v[28:29], v13 offset:2048
    ds_read_b64_tr_b16 v[30:31], v13 offset:2560
    s_waitcnt lgkmcnt(4)
    v_mfma_f32_32x32x16_bf16 v[48:63], v[20:23], a[64:67], v[48:63]
    ds_read_b64_tr_b16 v[16:17], v12 offset:4096
    ds_read_b64_tr_b16 v[18:19], v12 offset:4608
    s_waitcnt lgkmcnt(4)
    v_mfma_f32_32x32x16_bf16 v[32:47], v[24:27], a[68:71], v[32:47]
    ds_read_b64_tr_b16 v[20:21], v13 offset:4096
    ds_read_b64_tr_b16 v[22:23], v13 offset:4608
    s_waitcnt lgkmcnt(4)
    v_mfma_f32_32x32x16_bf16 v[48:63], v[28:31], a[68:71], v[48:63]
    ds_read_b64_tr_b16 v[24:25], v12 offset:6144
    ds_read_b64_tr_b16 v[26:27], v12 offset:6656
    s_waitcnt lgkmcnt(4)
    v_mfma_f32_32x32x16_bf16 v[32:47], v[16:19], a[72:75], v[32:47]
    ds_read_b64_tr_b16 v[28:29], v13 offset:6144
    ds_read_b64_tr_b16 v[30:31], v13 offset:6656
    s_waitcnt lgkmcnt(4)
    v_mfma_f32_32x32x16_bf16 v[48:63], v[20:23], a[72:75], v[48:63]
    ds_read_b64_tr_b16 v[16:17], v12 offset:16512
    ds_read_b64_tr_b16 v[18:19], v12 offset:17024
    s_waitcnt lgkmcnt(4)
    v_mfma_f32_32x32x16_bf16 v[32:47], v[24:27], a[76:79], v[32:47]
    ds_read_b64_tr_b16 v[20:21], v13 offset:16512
    ds_read_b64_tr_b16 v[22:23], v13 offset:17024
    s_waitcnt lgkmcnt(4)
    v_mfma_f32_32x32x16_bf16 v[48:63], v[28:31], a[76:79], v[48:63]
    ds_read_b64_tr_b16 v[24:25], v12 offset:18560
    ds_read_b64_tr_b16 v[26:27], v12 offset:19072
    s_waitcnt vmcnt(10)
    s_barrier
    s_waitcnt lgkmcnt(4)
    v_mfma_f32_32x32x16_bf16 v[32:47], v[16:19], a[80:83], v[32:47]
    ds_read_b64_tr_b16 v[28:29], v13 offset:18560
    ds_read_b64_tr_b16 v[30:31], v13 offset:19072
    s_waitcnt lgkmcnt(4)
    v_mfma_f32_32x32x16_bf16 v[48:63], v[20:23], a[80:83], v[48:63]
    ds_read_b64_tr_b16 v[16:17], v12 offset:20608
    ds_read_b64_tr_b16 v[18:19], v12 offset:21120
    s_waitcnt lgkmcnt(4)
    v_mfma_f32_32x32x16_bf16 v[32:47], v[24:27], a[84:87], v[32:47]
    ds_read_b64_tr_b16 v[20:21], v13 offset:20608
    ds_read_b64_tr_b16 v[22:23], v13 offset:21120
    s_waitcnt lgkmcnt(4)
    v_mfma_f32_32x32x16_bf16 v[48:63], v[28:31], a[84:87], v[48:63]
    ds_read_b64_tr_b16 v[24:25], v12 offset:22656
    ds_read_b64_tr_b16 v[26:27], v12 offset:23168
    s_waitcnt lgkmcnt(4)
    v_mfma_f32_32x32x16_bf16 v[32:47], v[16:19], a[88:91], v[32:47]
    ds_read_b64_tr_b16 v[28:29], v13 offset:22656
    ds_read_b64_tr_b16 v[30:31], v13 offset:23168
    s_waitcnt lgkmcnt(4)
    v_mfma_f32_32x32x16_bf16 v[48:63], v[20:23], a[88:91], v[48:63]
    ds_read_b64_tr_b16 v[16:17], v12 offset:33024
    ds_read_b64_tr_b16 v[18:19], v12 offset:33536
    s_waitcnt lgkmcnt(4)
    v_mfma_f32_32x32x16_bf16 v[32:47], v[24:27], a[92:95], v[32:47]
    ds_read_b64_tr_b16 v[20:21], v13 offset:33024
    ds_read_b64_tr_b16 v[22:23], v13 offset:33536
    s_waitcnt lgkmcnt(4)
    v_mfma_f32_32x32x16_bf16 v[48:63], v[28:31], a[92:95], v[48:63]
    ds_read_b64_tr_b16 v[24:25], v12 offset:35072
    ds_read_b64_tr_b16 v[26:27], v12 offset:35584
    s_waitcnt vmcnt(4)
    s_barrier
    s_waitcnt lgkmcnt(4)
    v_mfma_f32_32x32x16_bf16 v[32:47], v[16:19], a[96:99], v[32:47]
    ds_read_b64_tr_b16 v[28:29], v13 offset:35072
    ds_read_b64_tr_b16 v[30:31], v13 offset:35584
    s_waitcnt lgkmcnt(4)
    v_mfma_f32_32x32x16_bf16 v[48:63], v[20:23], a[96:99], v[48:63]
    ds_read_b64_tr_b16 v[16:17], v12 offset:37120
    ds_read_b64_tr_b16 v[18:19], v12 offset:37632
    s_waitcnt lgkmcnt(4)
    v_mfma_f32_32x32x16_bf16 v[32:47], v[24:27], a[100:103], v[32:47]
    ds_read_b64_tr_b16 v[20:21], v13 offset:37120
    ds_read_b64_tr_b16 v[22:23], v13 offset:37632
    s_waitcnt lgkmcnt(4)
    v_mfma_f32_32x32x16_bf16 v[48:63], v[28:31], a[100:103], v[48:63]
    ds_read_b64_tr_b16 v[24:25], v12 offset:39168
    ds_read_b64_tr_b16 v[26:27], v12 offset:39680
    s_waitcnt lgkmcnt(4)
    v_mfma_f32_32x32x16_bf16 v[32:47], v[16:19], a[104:107], v[32:47]
    ds_read_b64_tr_b16 v[28:29], v13 offset:39168
    ds_read_b64_tr_b16 v[30:31], v13 offset:39680
    s_waitcnt lgkmcnt(4)
    v_mfma_f32_32x32x16_bf16 v[48:63], v[20:23], a[104:107], v[48:63]
    ds_read_b64_tr_b16 v[16:17], v12 offset:49536
    ds_read_b64_tr_b16 v[18:19], v12 offset:50048
    s_waitcnt lgkmcnt(4)
    v_mfma_f32_32x32x16_bf16 v[32:47], v[24:27], a[108:111], v[32:47]
    ds_read_b64_tr_b16 v[20:21], v13 offset:49536
    ds_read_b64_tr_b16 v[22:23], v13 offset:50048
    s_waitcnt lgkmcnt(4)
    v_mfma_f32_32x32x16_bf16 v[48:63], v[28:31], a[108:111], v[48:63]
    ds_read_b64_tr_b16 v[24:25], v12 offset:51584
    ds_read_b64_tr_b16 v[26:27], v12 offset:52096
    s_waitcnt vmcnt(0)
    s_barrier
    s_waitcnt lgkmcnt(4)
    v_mfma_f32_32x32x16_bf16 v[32:47], v[16:19], a[112:115], v[32:47]
    ds_read_b64_tr_b16 v[28:29], v13 offset:51584
    ds_read_b64_tr_b16 v[30:31], v13 offset:52096
    s_waitcnt lgkmcnt(4)
    v_mfma_f32_32x32x16_bf16 v[48:63], v[20:23], a[112:115], v[48:63]
    ds_read_b64_tr_b16 v[16:17], v12 offset:53632
    ds_read_b64_tr_b16 v[18:19], v12 offset:54144
    s_waitcnt lgkmcnt(4)
    v_mfma_f32_32x32x16_bf16 v[32:47], v[24:27], a[116:119], v[32:47]
    ds_read_b64_tr_b16 v[20:21], v13 offset:53632
    ds_read_b64_tr_b16 v[22:23], v13 offset:54144
    s_waitcnt lgkmcnt(4)
    v_mfma_f32_32x32x16_bf16 v[48:63], v[28:31], a[116:119], v[48:63]
    ds_read_b64_tr_b16 v[24:25], v12 offset:55680
    ds_read_b64_tr_b16 v[26:27], v12 offset:56192
    s_waitcnt lgkmcnt(4)
    v_mfma_f32_32x32x16_bf16 v[32:47], v[16:19], a[120:123], v[32:47]
    ds_read_b64_tr_b16 v[28:29], v13 offset:55680
    ds_read_b64_tr_b16 v[30:31], v13 offset:56192
    s_waitcnt lgkmcnt(4)
    v_mfma_f32_32x32x16_bf16 v[48:63], v[20:23], a[120:123], v[48:63]
    s_waitcnt lgkmcnt(2)
    v_mfma_f32_32x32x16_bf16 v[32:47], v[24:27], a[124:127], v[32:47]
    s_waitcnt lgkmcnt(0)
    v_mfma_f32_32x32x16_bf16 v[48:63], v[28:31], a[124:127], v[48:63]
    s_cmp_ge_u32 s14, 28
    s_cbranch_scc1 L_k1_qepi
    s_mul_i32 s30, s31, 112
    s_lshl_b32 s29, s14, 2
    s_add_u32 s30, s30, s29
    s_lshl_b32 s30, s30, 10
    s_add_u32 s30, s30, 2097152
    ds_read_b64_tr_b16 v[16:17], v10 offset:0
    ds_read_b64_tr_b16 v[18:19], v10 offset:512
    ds_read_b64_tr_b16 v[20:21], v11 offset:0
    ds_read_b64_tr_b16 v[22:23], v11 offset:512
    ds_read_b64_tr_b16 v[24:25], v10 offset:2048
    ds_read_b64_tr_b16 v[26:27], v10 offset:2560
    s_waitcnt lgkmcnt(4)
    v_mfma_f32_32x32x16_bf16 v[64:79], v[16:19], a[0:3], 0
    ds_read_b64_tr_b16 v[28:29], v11 offset:2048
    ds_read_b64_tr_b16 v[30:31], v11 offset:2560
    v_cvt_pk_bf16_f32 v96, v32, v33
    v_cvt_pk_bf16_f32 v104, v34, v35
    v_cvt_pk_bf16_f32 v97, v40, v41
    v_cvt_pk_bf16_f32 v105, v42, v43
    s_waitcnt lgkmcnt(4)
    v_mfma_f32_32x32x16_bf16 v[80:95], v[20:23], a[0:3], 0
    ds_read_b64_tr_b16 v[16:17], v10 offset:4096
    ds_read_b64_tr_b16 v[18:19], v10 offset:4608
    v_lshlrev_b32 v98, 16, v96
    v_lshlrev_b32 v106, 16, v104
    v_and_b32 v99, 0xffff0000, v96
    v_and_b32 v107, 0xffff0000, v104
    s_waitcnt lgkmcnt(4)
    v_mfma_f32_32x32x16_bf16 v[64:79], v[24:27], a[4:7], v[64:79]
    ds_read_b64_tr_b16 v[20:21], v11 offset:4096
    ds_read_b64_tr_b16 v[22:23], v11 offset:4608
    v_lshlrev_b32 v100, 16, v97
    v_lshlrev_b32 v108, 16, v105
    v_and_b32 v101, 0xffff0000, v97
    v_and_b32 v109, 0xffff0000, v105
    s_waitcnt lgkmcnt(4)
    v_mfma_f32_32x32x16_bf16 v[80:95], v[28:31], a[4:7], v[80:95]
    ds_read_b64_tr_b16 v[24:25], v10 offset:6144
    ds_read_b64_tr_b16 v[26:27], v10 offset:6656
    v_mul_f32 v102, v98, v98
    v_mul_f32 v110, v106, v106
    v_mul_f32 v103, v99, v99
    v_mul_f32 v111, v107, v107
    s_waitcnt lgkmcnt(4)
    v_mfma_f32_32x32x16_bf16 v[64:79], v[16:19], a[8:11], v[64:79]
    ds_read_b64_tr_b16 v[28:29], v11 offset:6144
    ds_read_b64_tr_b16 v[30:31], v11 offset:6656
    v_mul_f32 v102, s42, v102
    v_mul_f32 v110, s42, v110
    v_mul_f32 v103, s43, v103
    v_mul_f32 v111, s43, v111
    s_waitcnt lgkmcnt(4)
    v_mfma_f32_32x32x16_bf16 v[80:95], v[20:23], a[8:11], v[80:95]
    ds_read_b64_tr_b16 v[16:17], v10 offset:16512
    ds_read_b64_tr_b16 v[18:19], v10 offset:17024
    v_add_f32 v102, s40, v102
    v_add_f32 v110, s40, v110
    v_add_f32 v103, s41, v103
    v_add_f32 v111, s41, v111
    s_waitcnt lgkmcnt(4)
    v_mfma_f32_32x32x16_bf16 v[64:79], v[24:27], a[12:15], v[64:79]
    ds_read_b64_tr_b16 v[20:21], v11 offset:16512
    ds_read_b64_tr_b16 v[22:23], v11 offset:17024
    v_mul_f32 v102, v102, v98
    v_mul_f32 v110, v110, v106
    v_mul_f32 v103, v103, v99
    v_mul_f32 v111, v111, v107
    s_waitcnt lgkmcnt(4)
    v_mfma_f32_32x32x16_bf16 v[80:95], v[28:31], a[12:15], v[80:95]
    ds_read_b64_tr_b16 v[24:25], v10 offset:18560
    ds_read_b64_tr_b16 v[26:27], v10 offset:19072
    v_exp_f32 v102, v102
    v_exp_f32 v110, v110
    v_exp_f32 v103, v103
    v_exp_f32 v111, v111
    s_waitcnt lgkmcnt(4)
    v_mfma_f32_32x32x16_bf16 v[64:79], v[16:19], a[16:19], v[64:79]
    ds_read_b64_tr_b16 v[28:29], v11 offset:18560
    ds_read_b64_tr_b16 v[30:31], v11 offset:19072
    v_add_f32 v102, s44, v102
    v_add_f32 v110, s44, v110
    v_add_f32 v103, s45, v103
    v_add_f32 v111, s45, v111
    s_waitcnt lgkmcnt(4)
    v_mfma_f32_32x32x16_bf16 v[80:95], v[20:23], a[16:19], v[80:95]
    ds_read_b64_tr_b16 v[16:17], v10 offset:20608
    ds_read_b64_tr_b16 v[18:19], v10 offset:21120
    v_rcp_f32 v102, v102
    v_rcp_f32 v110, v110
    v_rcp_f32 v103, v103
    v_rcp_f32 v111, v111
    s_waitcnt lgkmcnt(4)
    v_mfma_f32_32x32x16_bf16 v[64:79], v[24:27], a[20:23], v[64:79]
    ds_read_b64_tr_b16 v[20:21], v11 offset:20608
    ds_read_b64_tr_b16 v[22:23], v11 offset:21120
    v_mul_f32 v102, v102, v98
    v_mul_f32 v110, v110, v106
    v_mul_f32 v103, v103, v99
    v_mul_f32 v111, v111, v107
    s_waitcnt lgkmcnt(4)
    v_mfma_f32_32x32x16_bf16 v[80:95], v[28:31], a[20:23], v[80:95]
    ds_read_b64_tr_b16 v[24:25], v10 offset:22656
    ds_read_b64_tr_b16 v[26:27], v10 offset:23168
    v_cvt_pk_bf16_f32 v96, v102, v103
    v_cvt_pk_bf16_f32 v104, v110, v111
    v_lshlrev_b32 v102, 16, v96
    v_lshlrev_b32 v110, 16, v104
    s_waitcnt lgkmcnt(4)
    v_mfma_f32_32x32x16_bf16 v[64:79], v[16:19], a[24:27], v[64:79]
    ds_read_b64_tr_b16 v[28:29], v11 offset:22656
    ds_read_b64_tr_b16 v[30:31], v11 offset:23168
    v_and_b32 v103, 0xffff0000, v96
    v_and_b32 v111, 0xffff0000, v104
    v_mul_f32 v102, v102, v100
    v_mul_f32 v110, v110, v108
    s_waitcnt lgkmcnt(4)
    v_mfma_f32_32x32x16_bf16 v[80:95], v[20:23], a[24:27], v[80:95]
    ds_read_b64_tr_b16 v[16:17], v10 offset:33024
    ds_read_b64_tr_b16 v[18:19], v10 offset:33536
    v_mul_f32 v103, v103, v101
    v_mul_f32 v111, v111, v109
    v_cvt_pk_bf16_f32 v112, v102, v103
    v_cvt_pk_bf16_f32 v113, v110, v111
    s_waitcnt lgkmcnt(4)
    v_mfma_f32_32x32x16_bf16 v[64:79], v[24:27], a[28:31], v[64:79]
    ds_read_b64_tr_b16 v[20:21], v11 offset:33024
    ds_read_b64_tr_b16 v[22:23], v11 offset:33536
    v_cvt_pk_bf16_f32 v96, v36, v37
    v_cvt_pk_bf16_f32 v104, v38, v39
    v_cvt_pk_bf16_f32 v97, v44, v45
    v_cvt_pk_bf16_f32 v105, v46, v47
    s_waitcnt lgkmcnt(4)
    v_mfma_f32_32x32x16_bf16 v[80:95], v[28:31], a[28:31], v[80:95]
    ds_read_b64_tr_b16 v[24:25], v10 offset:35072
    ds_read_b64_tr_b16 v[26:27], v10 offset:35584
    v_lshlrev_b32 v98, 16, v96
    v_lshlrev_b32 v106, 16, v104
    v_and_b32 v99, 0xffff0000, v96
    v_and_b32 v107, 0xffff0000, v104
    s_barrier
    s_lshl_b32 s54, s16, 6
    s_add_u32 s54, s54, 0
    s_lshl_b32 s55, s54, 6
    s_cmp_ge_u32 s54, 256
    s_cselect_b32 s56, 128, 0
    s_add_u32 s55, s55, s56
    s_mov_b32 m0, s55
    s_mul_i32 s54, s54, 3072
    buffer_load_dwordx4 v4, s[32:35], s54 offen lds
    s_lshl_b32 s54, s16, 6
    s_add_u32 s54, s54, 16
    s_lshl_b32 s55, s54, 6
    s_cmp_ge_u32 s54, 256
    s_cselect_b32 s56, 128, 0
    s_add_u32 s55, s55, s56
    s_mov_b32 m0, s55
    s_mul_i32 s54, s54, 3072
    buffer_load_dwordx4 v4, s[32:35], s54 offen lds
    s_lshl_b32 s54, s16, 6
    s_add_u32 s54, s54, 32
    s_lshl_b32 s55, s54, 6
    s_cmp_ge_u32 s54, 256
    s_cselect_b32 s56, 128, 0
    s_add_u32 s55, s55, s56
    s_mov_b32 m0, s55
    s_mul_i32 s54, s54, 3072
    buffer_load_dwordx4 v4, s[32:35], s54 offen lds
    s_lshl_b32 s54, s16, 6
    s_add_u32 s54, s54, 48
    s_lshl_b32 s55, s54, 6
    s_cmp_ge_u32 s54, 256
    s_cselect_b32 s56, 128, 0
    s_add_u32 s55, s55, s56
    s_mov_b32 m0, s55
    s_mul_i32 s54, s54, 3072
    buffer_load_dwordx4 v4, s[32:35], s54 offen lds
    s_waitcnt lgkmcnt(4)
    v_mfma_f32_32x32x16_bf16 v[64:79], v[16:19], a[32:35], v[64:79]
    ds_read_b64_tr_b16 v[28:29], v11 offset:35072
    ds_read_b64_tr_b16 v[30:31], v11 offset:35584
    v_lshlrev_b32 v100, 16, v97
    v_lshlrev_b32 v108, 16, v105
    v_and_b32 v101, 0xffff0000, v97
    v_and_b32 v109, 0xffff0000, v105
    s_waitcnt lgkmcnt(4)
    v_mfma_f32_32x32x16_bf16 v[80:95], v[20:23], a[32:35], v[80:95]
    ds_read_b64_tr_b16 v[16:17], v10 offset:37120
    ds_read_b64_tr_b16 v[18:19], v10 offset:37632
    v_mul_f32 v102, v98, v98
    v_mul_f32 v110, v106, v106
    v_mul_f32 v103, v99, v99
    v_mul_f32 v111, v107, v107
    s_waitcnt lgkmcnt(4)
    v_mfma_f32_32x32x16_bf16 v[64:79], v[24:27], a[36:39], v[64:79]
    ds_read_b64_tr_b16 v[20:21], v11 offset:37120
    ds_read_b64_tr_b16 v[22:23], v11 offset:37632
    v_mul_f32 v102, s42, v102
    v_mul_f32 v110, s42, v110
    v_mul_f32 v103, s43, v103
    v_mul_f32 v111, s43, v111
    s_waitcnt lgkmcnt(4)
    v_mfma_f32_32x32x16_bf16 v[80:95], v[28:31], a[36:39], v[80:95]
    ds_read_b64_tr_b16 v[24:25], v10 offset:39168
    ds_read_b64_tr_b16 v[26:27], v10 offset:39680
    v_add_f32 v102, s40, v102
    v_add_f32 v110, s40, v110
    v_add_f32 v103, s41, v103
    v_add_f32 v111, s41, v111
    s_waitcnt lgkmcnt(4)
    v_mfma_f32_32x32x16_bf16 v[64:79], v[16:19], a[40:43], v[64:79]
    ds_read_b64_tr_b16 v[28:29], v11 offset:39168
    ds_read_b64_tr_b16 v[30:31], v11 offset:39680
    v_mul_f32 v102, v102, v98
    v_mul_f32 v110, v110, v106
    v_mul_f32 v103, v103, v99
    v_mul_f32 v111, v111, v107
    s_waitcnt lgkmcnt(4)
    v_mfma_f32_32x32x16_bf16 v[80:95], v[20:23], a[40:43], v[80:95]
    ds_read_b64_tr_b16 v[16:17], v10 offset:49536
    ds_read_b64_tr_b16 v[18:19], v10 offset:50048
    v_exp_f32 v102, v102
    v_exp_f32 v110, v110
    v_exp_f32 v103, v103
    v_exp_f32 v111, v111
    s_waitcnt lgkmcnt(4)
    v_mfma_f32_32x32x16_bf16 v[64:79], v[24:27], a[44:47], v[64:79]
    ds_read_b64_tr_b16 v[20:21], v11 offset:49536
    ds_read_b64_tr_b16 v[22:23], v11 offset:50048
    v_add_f32 v102, s44, v102
    v_add_f32 v110, s44, v110
    v_add_f32 v103, s45, v103
    v_add_f32 v111, s45, v111
    s_waitcnt lgkmcnt(4)
    v_mfma_f32_32x32x16_bf16 v[80:95], v[28:31], a[44:47], v[80:95]
    ds_read_b64_tr_b16 v[24:25], v10 offset:51584
    ds_read_b64_tr_b16 v[26:27], v10 offset:52096
    v_rcp_f32 v102, v102
    v_rcp_f32 v110, v110
    v_rcp_f32 v103, v103
    v_rcp_f32 v111, v111
    s_waitcnt lgkmcnt(4)
    v_mfma_f32_32x32x16_bf16 v[64:79], v[16:19], a[48:51], v[64:79]
    ds_read_b64_tr_b16 v[28:29], v11 offset:51584
    ds_read_b64_tr_b16 v[30:31], v11 offset:52096
    v_mul_f32 v102, v102, v98
    v_mul_f32 v110, v110, v106
    v_mul_f32 v103, v103, v99
    v_mul_f32 v111, v111, v107
    s_waitcnt lgkmcnt(4)
    v_mfma_f32_32x32x16_bf16 v[80:95], v[20:23], a[48:51], v[80:95]
    ds_read_b64_tr_b16 v[16:17], v10 offset:53632
    ds_read_b64_tr_b16 v[18:19], v10 offset:54144
    v_cvt_pk_bf16_f32 v96, v102, v103
    v_cvt_pk_bf16_f32 v104, v110, v111
    v_lshlrev_b32 v102, 16, v96
    v_lshlrev_b32 v110, 16, v104
    s_waitcnt lgkmcnt(4)
    v_mfma_f32_32x32x16_bf16 v[64:79], v[24:27], a[52:55], v[64:79]
    ds_read_b64_tr_b16 v[20:21], v11 offset:53632
    ds_read_b64_tr_b16 v[22:23], v11 offset:54144
    v_and_b32 v103, 0xffff0000, v96
    v_and_b32 v111, 0xffff0000, v104
    v_mul_f32 v102, v102, v100
    v_mul_f32 v110, v110, v108
    s_waitcnt lgkmcnt(4)
    v_mfma_f32_32x32x16_bf16 v[80:95], v[28:31], a[52:55], v[80:95]
    ds_read_b64_tr_b16 v[24:25], v10 offset:55680
    ds_read_b64_tr_b16 v[26:27], v10 offset:56192
    v_mul_f32 v103, v103, v101
    v_mul_f32 v111, v111, v109
    v_cvt_pk_bf16_f32 v114, v102, v103
    v_cvt_pk_bf16_f32 v115, v110, v111
    s_waitcnt lgkmcnt(4)
    v_mfma_f32_32x32x16_bf16 v[64:79], v[16:19], a[56:59], v[64:79]
    ds_read_b64_tr_b16 v[28:29], v11 offset:55680
    ds_read_b64_tr_b16 v[30:31], v11 offset:56192
    buffer_store_dwordx4 v[112:115], v7, s[20:23], s30 offen offset:0 sc1
    v_cvt_pk_bf16_f32 v96, v48, v49
    v_cvt_pk_bf16_f32 v104, v50, v51
    v_cvt_pk_bf16_f32 v97, v56, v57
    s_waitcnt lgkmcnt(4)
    v_mfma_f32_32x32x16_bf16 v[80:95], v[20:23], a[56:59], v[80:95]
    ds_read_b64_tr_b16 v[16:17], v14 offset:0
    ds_read_b64_tr_b16 v[18:19], v14 offset:512
    v_cvt_pk_bf16_f32 v105, v58, v59
    v_lshlrev_b32 v98, 16, v96
    v_lshlrev_b32 v106, 16, v104
    v_and_b32 v99, 0xffff0000, v96
    s_waitcnt lgkmcnt(4)
    v_mfma_f32_32x32x16_bf16 v[64:79], v[24:27], a[60:63], v[64:79]
    ds_read_b64_tr_b16 v[20:21], v15 offset:0
    ds_read_b64_tr_b16 v[22:23], v15 offset:512
    v_and_b32 v107, 0xffff0000, v104
    v_lshlrev_b32 v100, 16, v97
    v_lshlrev_b32 v108, 16, v105
    v_and_b32 v101, 0xffff0000, v97
    s_waitcnt lgkmcnt(4)
    v_mfma_f32_32x32x16_bf16 v[80:95], v[28:31], a[60:63], v[80:95]
    ds_read_b64_tr_b16 v[24:25], v14 offset:2048
    ds_read_b64_tr_b16 v[26:27], v14 offset:2560
    v_and_b32 v109, 0xffff0000, v105
    v_mul_f32 v102, v98, v98
    v_mul_f32 v110, v106, v106
    v_mul_f32 v103, v99, v99
    s_waitcnt lgkmcnt(4)
    v_mfma_f32_32x32x16_bf16 v[64:79], v[16:19], a[64:67], v[64:79]
    ds_read_b64_tr_b16 v[28:29], v15 offset:2048
    ds_read_b64_tr_b16 v[30:31], v15 offset:2560
    v_mul_f32 v111, v107, v107
    v_mul_f32 v102, s42, v102
    v_mul_f32 v110, s42, v110
    v_mul_f32 v103, s43, v103
    s_waitcnt lgkmcnt(4)
    v_mfma_f32_32x32x16_bf16 v[80:95], v[20:23], a[64:67], v[80:95]
    ds_read_b64_tr_b16 v[16:17], v14 offset:4096
    ds_read_b64_tr_b16 v[18:19], v14 offset:4608
    v_mul_f32 v111, s43, v111
    v_add_f32 v102, s40, v102
    v_add_f32 v110, s40, v110
    v_add_f32 v103, s41, v103
    s_waitcnt lgkmcnt(4)
    v_mfma_f32_32x32x16_bf16 v[64:79], v[24:27], a[68:71], v[64:79]
    ds_read_b64_tr_b16 v[20:21], v15 offset:4096
    ds_read_b64_tr_b16 v[22:23], v15 offset:4608
    v_add_f32 v111, s41, v111
    v_mul_f32 v102, v102, v98
    v_mul_f32 v110, v110, v106
    v_mul_f32 v103, v103, v99
    s_waitcnt lgkmcnt(4)
    v_mfma_f32_32x32x16_bf16 v[80:95], v[28:31], a[68:71], v[80:95]
    ds_read_b64_tr_b16 v[24:25], v14 offset:6144
    ds_read_b64_tr_b16 v[26:27], v14 offset:6656
    v_mul_f32 v111, v111, v107
    v_exp_f32 v102, v102
    v_exp_f32 v110, v110
    v_exp_f32 v103, v103
    s_waitcnt lgkmcnt(4)
    v_mfma_f32_32x32x16_bf16 v[64:79], v[16:19], a[72:75], v[64:79]
    ds_read_b64_tr_b16 v[28:29], v15 offset:6144
    ds_read_b64_tr_b16 v[30:31], v15 offset:6656
    v_exp_f32 v111, v111
    v_add_f32 v102, s44, v102
    v_add_f32 v110, s44, v110
    v_add_f32 v103, s45, v103
    s_waitcnt lgkmcnt(4)
    v_mfma_f32_32x32x16_bf16 v[80:95], v[20:23], a[72:75], v[80:95]
    ds_read_b64_tr_b16 v[16:17], v14 offset:16512
    ds_read_b64_tr_b16 v[18:19], v14 offset:17024
    v_add_f32 v111, s45, v111
    v_rcp_f32 v102, v102
    v_rcp_f32 v110, v110
    v_rcp_f32 v103, v103
    s_waitcnt lgkmcnt(4)
    v_mfma_f32_32x32x16_bf16 v[64:79], v[24:27], a[76:79], v[64:79]
    ds_read_b64_tr_b16 v[20:21], v15 offset:16512
    ds_read_b64_tr_b16 v[22:23], v15 offset:17024
    v_rcp_f32 v111, v111
    v_mul_f32 v102, v102, v98
    v_mul_f32 v110, v110, v106
    v_mul_f32 v103, v103, v99
    s_waitcnt lgkmcnt(4)
    v_mfma_f32_32x32x16_bf16 v[80:95], v[28:31], a[76:79], v[80:95]
    ds_read_b64_tr_b16 v[24:25], v14 offset:18560
    ds_read_b64_tr_b16 v[26:27], v14 offset:19072
    v_mul_f32 v111, v111, v107
    v_cvt_pk_bf16_f32 v96, v102, v103
    v_cvt_pk_bf16_f32 v104, v110, v111
    v_lshlrev_b32 v102, 16, v96
    s_waitcnt lgkmcnt(4)
    v_mfma_f32_32x32x16_bf16 v[64:79], v[16:19], a[80:83], v[64:79]
    ds_read_b64_tr_b16 v[28:29], v15 offset:18560
    ds_read_b64_tr_b16 v[30:31], v15 offset:19072
    v_lshlrev_b32 v110, 16, v104
    v_and_b32 v103, 0xffff0000, v96
    v_and_b32 v111, 0xffff0000, v104
    v_mul_f32 v102, v102, v100
    s_waitcnt lgkmcnt(4)
    v_mfma_f32_32x32x16_bf16 v[80:95], v[20:23], a[80:83], v[80:95]
    ds_read_b64_tr_b16 v[16:17], v14 offset:20608
    ds_read_b64_tr_b16 v[18:19], v14 offset:21120
    v_mul_f32 v110, v110, v108
    v_mul_f32 v103, v103, v101
    v_mul_f32 v111, v111, v109
    v_cvt_pk_bf16_f32 v116, v102, v103
    s_waitcnt lgkmcnt(4)
    v_mfma_f32_32x32x16_bf16 v[64:79], v[24:27], a[84:87], v[64:79]
    ds_read_b64_tr_b16 v[20:21], v15 offset:20608
    ds_read_b64_tr_b16 v[22:23], v15 offset:21120
    v_cvt_pk_bf16_f32 v117, v110, v111
    v_cvt_pk_bf16_f32 v96, v52, v53
    v_cvt_pk_bf16_f32 v104, v54, v55
    v_cvt_pk_bf16_f32 v97, v60, v61
    s_waitcnt lgkmcnt(4)
    v_mfma_f32_32x32x16_bf16 v[80:95], v[28:31], a[84:87], v[80:95]
    ds_read_b64_tr_b16 v[24:25], v14 offset:22656
    ds_read_b64_tr_b16 v[26:27], v14 offset:23168
    v_cvt_pk_bf16_f32 v105, v62, v63
    v_lshlrev_b32 v98, 16, v96
    v_lshlrev_b32 v106, 16, v104
    v_and_b32 v99, 0xffff0000, v96
    s_waitcnt lgkmcnt(4)
    v_mfma_f32_32x32x16_bf16 v[64:79], v[16:19], a[88:91], v[64:79]
    ds_read_b64_tr_b16 v[28:29], v15 offset:22656
    ds_read_b64_tr_b16 v[30:31], v15 offset:23168
    v_and_b32 v107, 0xffff0000, v104
    v_lshlrev_b32 v100, 16, v97
    v_lshlrev_b32 v108, 16, v105
    v_and_b32 v101, 0xffff0000, v97
    s_waitcnt lgkmcnt(4)
    v_mfma_f32_32x32x16_bf16 v[80:95], v[20:23], a[88:91], v[80:95]
    ds_read_b64_tr_b16 v[16:17], v14 offset:33024
    ds_read_b64_tr_b16 v[18:19], v14 offset:33536
    v_and_b32 v109, 0xffff0000, v105
    v_mul_f32 v102, v98, v98
    v_mul_f32 v110, v106, v106
    v_mul_f32 v103, v99, v99
    s_waitcnt lgkmcnt(4)
    v_mfma_f32_32x32x16_bf16 v[64:79], v[24:27], a[92:95], v[64:79]
    ds_read_b64_tr_b16 v[20:21], v15 offset:33024
    ds_read_b64_tr_b16 v[22:23], v15 offset:33536
    v_mul_f32 v111, v107, v107
    v_mul_f32 v102, s42, v102
    v_mul_f32 v110, s42, v110
    v_mul_f32 v103, s43, v103
    s_waitcnt lgkmcnt(4)
    v_mfma_f32_32x32x16_bf16 v[80:95], v[28:31], a[92:95], v[80:95]
    ds_read_b64_tr_b16 v[24:25], v14 offset:35072
    ds_read_b64_tr_b16 v[26:27], v14 offset:35584
    v_mul_f32 v111, s43, v111
    v_add_f32 v102, s40, v102
    v_add_f32 v110, s40, v110
    v_add_f32 v103, s41, v103
    s_waitcnt lgkmcnt(4)
    v_mfma_f32_32x32x16_bf16 v[64:79], v[16:19], a[96:99], v[64:79]
    ds_read_b64_tr_b16 v[28:29], v15 offset:35072
    ds_read_b64_tr_b16 v[30:31], v15 offset:35584
    v_add_f32 v111, s41, v111
    v_mul_f32 v102, v102, v98
    v_mul_f32 v110, v110, v106
    v_mul_f32 v103, v103, v99
    s_waitcnt lgkmcnt(4)
    v_mfma_f32_32x32x16_bf16 v[80:95], v[20:23], a[96:99], v[80:95]
    ds_read_b64_tr_b16 v[16:17], v14 offset:37120
    ds_read_b64_tr_b16 v[18:19], v14 offset:37632
    v_mul_f32 v111, v111, v107
    v_exp_f32 v102, v102
    v_exp_f32 v110, v110
    v_exp_f32 v103, v103
    s_waitcnt lgkmcnt(4)
    v_mfma_f32_32x32x16_bf16 v[64:79], v[24:27], a[100:103], v[64:79]
    ds_read_b64_tr_b16 v[20:21], v15 offset:37120
    ds_read_b64_tr_b16 v[22:23], v15 offset:37632
    v_exp_f32 v111, v111
    v_add_f32 v102, s44, v102
    v_add_f32 v110, s44, v110
    v_add_f32 v103, s45, v103
    s_waitcnt lgkmcnt(4)
    v_mfma_f32_32x32x16_bf16 v[80:95], v[28:31], a[100:103], v[80:95]
    ds_read_b64_tr_b16 v[24:25], v14 offset:39168
    ds_read_b64_tr_b16 v[26:27], v14 offset:39680
    v_add_f32 v111, s45, v111
    v_rcp_f32 v102, v102
    v_rcp_f32 v110, v110
    v_rcp_f32 v103, v103
    s_waitcnt lgkmcnt(4)
    v_mfma_f32_32x32x16_bf16 v[64:79], v[16:19], a[104:107], v[64:79]
    ds_read_b64_tr_b16 v[28:29], v15 offset:39168
    ds_read_b64_tr_b16 v[30:31], v15 offset:39680
    v_rcp_f32 v111, v111
    v_mul_f32 v102, v102, v98
    v_mul_f32 v110, v110, v106
    v_mul_f32 v103, v103, v99
    s_waitcnt lgkmcnt(4)
    v_mfma_f32_32x32x16_bf16 v[80:95], v[20:23], a[104:107], v[80:95]
    ds_read_b64_tr_b16 v[16:17], v14 offset:49536
    ds_read_b64_tr_b16 v[18:19], v14 offset:50048
    v_mul_f32 v111, v111, v107
    v_cvt_pk_bf16_f32 v96, v102, v103
    v_cvt_pk_bf16_f32 v104, v110, v111
    v_lshlrev_b32 v102, 16, v96
    s_waitcnt lgkmcnt(4)
    v_mfma_f32_32x32x16_bf16 v[64:79], v[24:27], a[108:111], v[64:79]
    ds_read_b64_tr_b16 v[20:21], v15 offset:49536
    ds_read_b64_tr_b16 v[22:23], v15 offset:50048
    v_lshlrev_b32 v110, 16, v104
    v_and_b32 v103, 0xffff0000, v96
    v_and_b32 v111, 0xffff0000, v104
    v_mul_f32 v102, v102, v100
    s_waitcnt lgkmcnt(4)
    v_mfma_f32_32x32x16_bf16 v[80:95], v[28:31], a[108:111], v[80:95]
    ds_read_b64_tr_b16 v[24:25], v14 offset:51584
    ds_read_b64_tr_b16 v[26:27], v14 offset:52096
    v_mul_f32 v110, v110, v108
    v_mul_f32 v103, v103, v101
    v_mul_f32 v111, v111, v109
    v_cvt_pk_bf16_f32 v118, v102, v103
    s_waitcnt lgkmcnt(4)
    v_mfma_f32_32x32x16_bf16 v[64:79], v[16:19], a[112:115], v[64:79]
    ds_read_b64_tr_b16 v[28:29], v15 offset:51584
    ds_read_b64_tr_b16 v[30:31], v15 offset:52096
    v_cvt_pk_bf16_f32 v119, v110, v111
    buffer_store_dwordx4 v[116:119], v7, s[20:23], s30 offen offset:1024 sc1
    s_waitcnt lgkmcnt(4)
    v_mfma_f32_32x32x16_bf16 v[80:95], v[20:23], a[112:115], v[80:95]
    ds_read_b64_tr_b16 v[16:17], v14 offset:53632
    ds_read_b64_tr_b16 v[18:19], v14 offset:54144
    s_waitcnt lgkmcnt(4)
    v_mfma_f32_32x32x16_bf16 v[64:79], v[24:27], a[116:119], v[64:79]
    ds_read_b64_tr_b16 v[20:21], v15 offset:53632
    ds_read_b64_tr_b16 v[22:23], v15 offset:54144
    s_waitcnt lgkmcnt(4)
    v_mfma_f32_32x32x16_bf16 v[80:95], v[28:31], a[116:119], v[80:95]
    ds_read_b64_tr_b16 v[24:25], v14 offset:55680
    ds_read_b64_tr_b16 v[26:27], v14 offset:56192
    s_waitcnt lgkmcnt(4)
    v_mfma_f32_32x32x16_bf16 v[64:79], v[16:19], a[120:123], v[64:79]
    ds_read_b64_tr_b16 v[28:29], v15 offset:55680
    ds_read_b64_tr_b16 v[30:31], v15 offset:56192
    s_waitcnt lgkmcnt(4)
    v_mfma_f32_32x32x16_bf16 v[80:95], v[20:23], a[120:123], v[80:95]
    s_waitcnt lgkmcnt(2)
    v_mfma_f32_32x32x16_bf16 v[64:79], v[24:27], a[124:127], v[64:79]
    s_waitcnt lgkmcnt(0)
    v_mfma_f32_32x32x16_bf16 v[80:95], v[28:31], a[124:127], v[80:95]
    s_waitcnt vmcnt(0)
    s_barrier
    ds_read_b64_tr_b16 v[16:17], v6 offset:0
    ds_read_b64_tr_b16 v[18:19], v6 offset:256
    ds_read_b64_tr_b16 v[20:21], v6 offset:1024
    ds_read_b64_tr_b16 v[22:23], v6 offset:1280
    ds_read_b64_tr_b16 v[24:25], v6 offset:2048
    ds_read_b64_tr_b16 v[26:27], v6 offset:2304
    s_waitcnt lgkmcnt(4)
    v_mfma_f32_32x32x16_bf16 v[112:127], a[0:3], v[16:19], 0
    ds_read_b64_tr_b16 v[28:29], v6 offset:3072
    ds_read_b64_tr_b16 v[30:31], v6 offset:3328
    v_cvt_pk_bf16_f32 v96, v64, v65
    v_cvt_pk_bf16_f32 v104, v66, v67
    v_cvt_pk_bf16_f32 v97, v72, v73
    v_cvt_pk_bf16_f32 v105, v74, v75
    v_lshlrev_b32 v98, 16, v96
    v_lshlrev_b32 v106, 16, v104
    v_and_b32 v99, 0xffff0000, v96
    v_and_b32 v107, 0xffff0000, v104
    s_waitcnt lgkmcnt(4)
    v_mfma_f32_32x32x16_bf16 v[112:127], a[4:7], v[20:23], v[112:127]
    ds_read_b64_tr_b16 v[16:17], v6 offset:4096
    ds_read_b64_tr_b16 v[18:19], v6 offset:4352
    v_lshlrev_b32 v100, 16, v97
    v_lshlrev_b32 v108, 16, v105
    v_and_b32 v101, 0xffff0000, v97
    v_and_b32 v109, 0xffff0000, v105
    v_mul_f32 v102, v98, v98
    v_mul_f32 v110, v106, v106
    v_mul_f32 v103, v99, v99
    v_mul_f32 v111, v107, v107
    s_waitcnt lgkmcnt(4)
    v_mfma_f32_32x32x16_bf16 v[112:127], a[8:11], v[24:27], v[112:127]
    ds_read_b64_tr_b16 v[20:21], v6 offset:5120
    ds_read_b64_tr_b16 v[22:23], v6 offset:5376
    v_mul_f32 v102, s42, v102
    v_mul_f32 v110, s42, v110
    v_mul_f32 v103, s43, v103
    v_mul_f32 v111, s43, v111
    v_add_f32 v102, s40, v102
    v_add_f32 v110, s40, v110
    v_add_f32 v103, s41, v103
    v_add_f32 v111, s41, v111
    s_waitcnt lgkmcnt(4)
    v_mfma_f32_32x32x16_bf16 v[112:127], a[12:15], v[28:31], v[112:127]
    ds_read_b64_tr_b16 v[24:25], v6 offset:6144
    ds_read_b64_tr_b16 v[26:27], v6 offset:6400
    v_mul_f32 v102, v102, v98
    v_mul_f32 v110, v110, v106
    v_mul_f32 v103, v103, v99
    v_mul_f32 v111, v111, v107
    v_exp_f32 v102, v102
    v_exp_f32 v110, v110
    v_exp_f32 v103, v103
    v_exp_f32 v111, v111
    s_waitcnt lgkmcnt(4)
    v_mfma_f32_32x32x16_bf16 v[112:127], a[16:19], v[16:19], v[112:127]
    ds_read_b64_tr_b16 v[28:29], v6 offset:7168
    ds_read_b64_tr_b16 v[30:31], v6 offset:7424
    v_add_f32 v102, s44, v102
    v_add_f32 v110, s44, v110
    v_add_f32 v103, s45, v103
    v_add_f32 v111, s45, v111
    v_rcp_f32 v102, v102
    v_rcp_f32 v110, v110
    v_rcp_f32 v103, v103
    v_rcp_f32 v111, v111
    s_waitcnt lgkmcnt(4)
    v_mfma_f32_32x32x16_bf16 v[112:127], a[20:23], v[20:23], v[112:127]
    ds_read_b64_tr_b16 v[16:17], v6 offset:8192
    ds_read_b64_tr_b16 v[18:19], v6 offset:8448
    v_mul_f32 v102, v102, v98
    v_mul_f32 v110, v110, v106
    v_mul_f32 v103, v103, v99
    v_mul_f32 v111, v111, v107
    v_cvt_pk_bf16_f32 v96, v102, v103
    v_cvt_pk_bf16_f32 v104, v110, v111
    v_lshlrev_b32 v102, 16, v96
    v_lshlrev_b32 v110, 16, v104
    s_waitcnt lgkmcnt(4)
    v_mfma_f32_32x32x16_bf16 v[112:127], a[24:27], v[24:27], v[112:127]
    ds_read_b64_tr_b16 v[20:21], v6 offset:9216
    ds_read_b64_tr_b16 v[22:23], v6 offset:9472
    v_and_b32 v103, 0xffff0000, v96
    v_and_b32 v111, 0xffff0000, v104
    v_mul_f32 v102, v102, v100
    v_mul_f32 v110, v110, v108
    v_mul_f32 v103, v103, v101
    v_mul_f32 v111, v111, v109
    v_cvt_pk_bf16_f32 v8, v102, v103
    v_cvt_pk_bf16_f32 v9, v110, v111
    s_waitcnt lgkmcnt(4)
    v_mfma_f32_32x32x16_bf16 v[112:127], a[28:31], v[28:31], v[112:127]
    ds_read_b64_tr_b16 v[24:25], v6 offset:10240
    ds_read_b64_tr_b16 v[26:27], v6 offset:10496
    v_cvt_pk_bf16_f32 v96, v68, v69
    v_cvt_pk_bf16_f32 v104, v70, v71
    v_cvt_pk_bf16_f32 v97, v76, v77
    v_cvt_pk_bf16_f32 v105, v78, v79
    v_lshlrev_b32 v98, 16, v96
    v_lshlrev_b32 v106, 16, v104
    v_and_b32 v99, 0xffff0000, v96
    v_and_b32 v107, 0xffff0000, v104
    s_waitcnt lgkmcnt(4)
    v_mfma_f32_32x32x16_bf16 v[112:127], a[32:35], v[16:19], v[112:127]
    ds_read_b64_tr_b16 v[28:29], v6 offset:11264
    ds_read_b64_tr_b16 v[30:31], v6 offset:11520
    v_lshlrev_b32 v100, 16, v97
    v_lshlrev_b32 v108, 16, v105
    v_and_b32 v101, 0xffff0000, v97
    v_and_b32 v109, 0xffff0000, v105
    v_mul_f32 v102, v98, v98
    v_mul_f32 v110, v106, v106
    v_mul_f32 v103, v99, v99
    v_mul_f32 v111, v107, v107
    s_waitcnt lgkmcnt(4)
    v_mfma_f32_32x32x16_bf16 v[112:127], a[36:39], v[20:23], v[112:127]
    ds_read_b64_tr_b16 v[16:17], v6 offset:12288
    ds_read_b64_tr_b16 v[18:19], v6 offset:12544
    v_mul_f32 v102, s42, v102
    v_mul_f32 v110, s42, v110
    v_mul_f32 v103, s43, v103
    v_mul_f32 v111, s43, v111
    v_add_f32 v102, s40, v102
    v_add_f32 v110, s40, v110
    v_add_f32 v103, s41, v103
    v_add_f32 v111, s41, v111
    s_waitcnt lgkmcnt(4)
    v_mfma_f32_32x32x16_bf16 v[112:127], a[40:43], v[24:27], v[112:127]
    ds_read_b64_tr_b16 v[20:21], v6 offset:13312
    ds_read_b64_tr_b16 v[22:23], v6 offset:13568
    v_mul_f32 v102, v102, v98
    v_mul_f32 v110, v110, v106
    v_mul_f32 v103, v103, v99
    v_mul_f32 v111, v111, v107
    v_exp_f32 v102, v102
    v_exp_f32 v110, v110
    v_exp_f32 v103, v103
    v_exp_f32 v111, v111
    s_waitcnt lgkmcnt(4)
    v_mfma_f32_32x32x16_bf16 v[112:127], a[44:47], v[28:31], v[112:127]
    ds_read_b64_tr_b16 v[24:25], v6 offset:14336
    ds_read_b64_tr_b16 v[26:27], v6 offset:14592
    v_add_f32 v102, s44, v102
    v_add_f32 v110, s44, v110
    v_add_f32 v103, s45, v103
    v_add_f32 v111, s45, v111
    v_rcp_f32 v102, v102
    v_rcp_f32 v110, v110
    v_rcp_f32 v103, v103
    v_rcp_f32 v111, v111
    s_waitcnt lgkmcnt(4)
    v_mfma_f32_32x32x16_bf16 v[112:127], a[48:51], v[16:19], v[112:127]
    ds_read_b64_tr_b16 v[28:29], v6 offset:15360
    ds_read_b64_tr_b16 v[30:31], v6 offset:15616
    v_mul_f32 v102, v102, v98
    v_mul_f32 v110, v110, v106
    v_mul_f32 v103, v103, v99
    v_mul_f32 v111, v111, v107
    v_cvt_pk_bf16_f32 v96, v102, v103
    v_cvt_pk_bf16_f32 v104, v110, v111
    v_lshlrev_b32 v102, 16, v96
    v_lshlrev_b32 v110, 16, v104
    s_waitcnt lgkmcnt(4)
    v_mfma_f32_32x32x16_bf16 v[112:127], a[52:55], v[20:23], v[112:127]
    ds_read_b64_tr_b16 v[16:17], v6 offset:16512
    ds_read_b64_tr_b16 v[18:19], v6 offset:16768
    v_and_b32 v103, 0xffff0000, v96
    v_and_b32 v111, 0xffff0000, v104
    v_mul_f32 v102, v102, v100
    v_mul_f32 v110, v110, v108
    v_mul_f32 v103, v103, v101
    v_mul_f32 v111, v111, v109
    v_cvt_pk_bf16_f32 v10, v102, v103
    v_cvt_pk_bf16_f32 v11, v110, v111
    s_waitcnt lgkmcnt(4)
    v_mfma_f32_32x32x16_bf16 v[112:127], a[56:59], v[24:27], v[112:127]
    ds_read_b64_tr_b16 v[20:21], v6 offset:17536
    ds_read_b64_tr_b16 v[22:23], v6 offset:17792
    buffer_store_dwordx4 v[8:11], v7, s[20:23], s30 offen offset:2048 sc1
    v_cvt_pk_bf16_f32 v96, v80, v81
    v_cvt_pk_bf16_f32 v104, v82, v83
    v_cvt_pk_bf16_f32 v97, v88, v89
    v_cvt_pk_bf16_f32 v105, v90, v91
    v_lshlrev_b32 v98, 16, v96
    v_lshlrev_b32 v106, 16, v104
    v_and_b32 v99, 0xffff0000, v96
    s_waitcnt lgkmcnt(4)
    v_mfma_f32_32x32x16_bf16 v[112:127], a[60:63], v[28:31], v[112:127]
    ds_read_b64_tr_b16 v[24:25], v6 offset:18560
    ds_read_b64_tr_b16 v[26:27], v6 offset:18816
    v_and_b32 v107, 0xffff0000, v104
    v_lshlrev_b32 v100, 16, v97
    v_lshlrev_b32 v108, 16, v105
    v_and_b32 v101, 0xffff0000, v97
    v_and_b32 v109, 0xffff0000, v105
    v_mul_f32 v102, v98, v98
    v_mul_f32 v110, v106, v106
    v_mul_f32 v103, v99, v99
    s_waitcnt lgkmcnt(4)
    v_mfma_f32_32x32x16_bf16 v[112:127], a[64:67], v[16:19], v[112:127]
    ds_read_b64_tr_b16 v[28:29], v6 offset:19584
    ds_read_b64_tr_b16 v[30:31], v6 offset:19840
    v_mul_f32 v111, v107, v107
    v_mul_f32 v102, s42, v102
    v_mul_f32 v110, s42, v110
    v_mul_f32 v103, s43, v103
    v_mul_f32 v111, s43, v111
    v_add_f32 v102, s40, v102
    v_add_f32 v110, s40, v110
    v_add_f32 v103, s41, v103
    s_waitcnt lgkmcnt(4)
    v_mfma_f32_32x32x16_bf16 v[112:127], a[68:71], v[20:23], v[112:127]
    ds_read_b64_tr_b16 v[16:17], v6 offset:20608
    ds_read_b64_tr_b16 v[18:19], v6 offset:20864
    v_add_f32 v111, s41, v111
    v_mul_f32 v102, v102, v98
    v_mul_f32 v110, v110, v106
    v_mul_f32 v103, v103, v99
    v_mul_f32 v111, v111, v107
    v_exp_f32 v102, v102
    v_exp_f32 v110, v110
    v_exp_f32 v103, v103
    s_waitcnt lgkmcnt(4)
    v_mfma_f32_32x32x16_bf16 v[112:127], a[72:75], v[24:27], v[112:127]
    ds_read_b64_tr_b16 v[20:21], v6 offset:21632
    ds_read_b64_tr_b16 v[22:23], v6 offset:21888
    v_exp_f32 v111, v111
    v_add_f32 v102, s44, v102
    v_add_f32 v110, s44, v110
    v_add_f32 v103, s45, v103
    v_add_f32 v111, s45, v111
    v_rcp_f32 v102, v102
    v_rcp_f32 v110, v110
    v_rcp_f32 v103, v103
    s_waitcnt lgkmcnt(4)
    v_mfma_f32_32x32x16_bf16 v[112:127], a[76:79], v[28:31], v[112:127]
    ds_read_b64_tr_b16 v[24:25], v6 offset:22656
    ds_read_b64_tr_b16 v[26:27], v6 offset:22912
    v_rcp_f32 v111, v111
    v_mul_f32 v102, v102, v98
    v_mul_f32 v110, v110, v106
    v_mul_f32 v103, v103, v99
    v_mul_f32 v111, v111, v107
    v_cvt_pk_bf16_f32 v96, v102, v103
    v_cvt_pk_bf16_f32 v104, v110, v111
    v_lshlrev_b32 v102, 16, v96
    s_waitcnt lgkmcnt(4)
    v_mfma_f32_32x32x16_bf16 v[112:127], a[80:83], v[16:19], v[112:127]
    ds_read_b64_tr_b16 v[28:29], v6 offset:23680
    ds_read_b64_tr_b16 v[30:31], v6 offset:23936
    v_lshlrev_b32 v110, 16, v104
    v_and_b32 v103, 0xffff0000, v96
    v_and_b32 v111, 0xffff0000, v104
    v_mul_f32 v102, v102, v100
    v_mul_f32 v110, v110, v108
    v_mul_f32 v103, v103, v101
    v_mul_f32 v111, v111, v109
    v_cvt_pk_bf16_f32 v12, v102, v103
    s_waitcnt lgkmcnt(4)
    v_mfma_f32_32x32x16_bf16 v[112:127], a[84:87], v[20:23], v[112:127]
    ds_read_b64_tr_b16 v[16:17], v6 offset:24704
    ds_read_b64_tr_b16 v[18:19], v6 offset:24960
    v_cvt_pk_bf16_f32 v13, v110, v111
    v_cvt_pk_bf16_f32 v96, v84, v85
    v_cvt_pk_bf16_f32 v104, v86, v87
    v_cvt_pk_bf16_f32 v97, v92, v93
    v_cvt_pk_bf16_f32 v105, v94, v95
    v_lshlrev_b32 v98, 16, v96
    v_lshlrev_b32 v106, 16, v104
    v_and_b32 v99, 0xffff0000, v96
    s_waitcnt lgkmcnt(4)
    v_mfma_f32_32x32x16_bf16 v[112:127], a[88:91], v[24:27], v[112:127]
    ds_read_b64_tr_b16 v[20:21], v6 offset:25728
    ds_read_b64_tr_b16 v[22:23], v6 offset:25984
    v_and_b32 v107, 0xffff0000, v104
    v_lshlrev_b32 v100, 16, v97
    v_lshlrev_b32 v108, 16, v105
    v_and_b32 v101, 0xffff0000, v97
    v_and_b32 v109, 0xffff0000, v105
    v_mul_f32 v102, v98, v98
    v_mul_f32 v110, v106, v106
    v_mul_f32 v103, v99, v99
    s_waitcnt lgkmcnt(4)
    v_mfma_f32_32x32x16_bf16 v[112:127], a[92:95], v[28:31], v[112:127]
    ds_read_b64_tr_b16 v[24:25], v6 offset:26752
    ds_read_b64_tr_b16 v[26:27], v6 offset:27008
    v_mul_f32 v111, v107, v107
    v_mul_f32 v102, s42, v102
    v_mul_f32 v110, s42, v110
    v_mul_f32 v103, s43, v103
    v_mul_f32 v111, s43, v111
    v_add_f32 v102, s40, v102
    v_add_f32 v110, s40, v110
    v_add_f32 v103, s41, v103
    s_waitcnt lgkmcnt(4)
    v_mfma_f32_32x32x16_bf16 v[112:127], a[96:99], v[16:19], v[112:127]
    ds_read_b64_tr_b16 v[28:29], v6 offset:27776
    ds_read_b64_tr_b16 v[30:31], v6 offset:28032
    v_add_f32 v111, s41, v111
    v_mul_f32 v102, v102, v98
    v_mul_f32 v110, v110, v106
    v_mul_f32 v103, v103, v99
    v_mul_f32 v111, v111, v107
    v_exp_f32 v102, v102
    v_exp_f32 v110, v110
    v_exp_f32 v103, v103
    s_waitcnt lgkmcnt(4)
    v_mfma_f32_32x32x16_bf16 v[112:127], a[100:103], v[20:23], v[112:127]
    ds_read_b64_tr_b16 v[16:17], v6 offset:28800
    ds_read_b64_tr_b16 v[18:19], v6 offset:29056
    v_exp_f32 v111, v111
    v_add_f32 v102, s44, v102
    v_add_f32 v110, s44, v110
    v_add_f32 v103, s45, v103
    v_add_f32 v111, s45, v111
    v_rcp_f32 v102, v102
    v_rcp_f32 v110, v110
    v_rcp_f32 v103, v103
    s_waitcnt lgkmcnt(4)
    v_mfma_f32_32x32x16_bf16 v[112:127], a[104:107], v[24:27], v[112:127]
    ds_read_b64_tr_b16 v[20:21], v6 offset:29824
    ds_read_b64_tr_b16 v[22:23], v6 offset:30080
    v_rcp_f32 v111, v111
    v_mul_f32 v102, v102, v98
    v_mul_f32 v110, v110, v106
    v_mul_f32 v103, v103, v99
    v_mul_f32 v111, v111, v107
    v_cvt_pk_bf16_f32 v96, v102, v103
    v_cvt_pk_bf16_f32 v104, v110, v111
    v_lshlrev_b32 v102, 16, v96
    s_waitcnt lgkmcnt(4)
    v_mfma_f32_32x32x16_bf16 v[112:127], a[108:111], v[28:31], v[112:127]
    ds_read_b64_tr_b16 v[24:25], v6 offset:30848
    ds_read_b64_tr_b16 v[26:27], v6 offset:31104
    v_lshlrev_b32 v110, 16, v104
    v_and_b32 v103, 0xffff0000, v96
    v_and_b32 v111, 0xffff0000, v104
    v_mul_f32 v102, v102, v100
    v_mul_f32 v110, v110, v108
    v_mul_f32 v103, v103, v101
    v_mul_f32 v111, v111, v109
    v_cvt_pk_bf16_f32 v14, v102, v103
    s_waitcnt lgkmcnt(4)
    v_mfma_f32_32x32x16_bf16 v[112:127], a[112:115], v[16:19], v[112:127]
    ds_read_b64_tr_b16 v[28:29], v6 offset:31872
    ds_read_b64_tr_b16 v[30:31], v6 offset:32128
    v_cvt_pk_bf16_f32 v15, v110, v111
    buffer_store_dwordx4 v[12:15], v7, s[20:23], s30 offen offset:3072 sc1
    s_waitcnt lgkmcnt(4)
    v_mfma_f32_32x32x16_bf16 v[112:127], a[116:119], v[20:23], v[112:127]
    s_waitcnt lgkmcnt(2)
    v_mfma_f32_32x32x16_bf16 v[112:127], a[120:123], v[24:27], v[112:127]
    s_waitcnt lgkmcnt(0)
    v_mfma_f32_32x32x16_bf16 v[112:127], a[124:127], v[28:31], v[112:127]
    s_branch L_k1_kvepi
L_k1_qepi:
    s_lshl_b32 s30, s31, 5
    s_sub_u32 s29, s14, 28
    s_lshl_b32 s29, s29, 3
    s_add_u32 s30, s30, s29
    s_lshl_b32 s30, s30, 10
    s_add_u32 s30, s30, 9437184
    s_add_u32 s29, s30, 4096
    ds_read_b64_tr_b16 v[16:17], v10 offset:0
    ds_read_b64_tr_b16 v[18:19], v10 offset:512
    ds_read_b64_tr_b16 v[20:21], v11 offset:0
    ds_read_b64_tr_b16 v[22:23], v11 offset:512
    ds_read_b64_tr_b16 v[24:25], v10 offset:2048
    ds_read_b64_tr_b16 v[26:27], v10 offset:2560
    s_waitcnt lgkmcnt(4)
    v_mfma_f32_32x32x16_bf16 v[64:79], v[16:19], a[0:3], 0
    ds_read_b64_tr_b16 v[28:29], v11 offset:2048
    ds_read_b64_tr_b16 v[30:31], v11 offset:2560
    v_cvt_pk_bf16_f32 v96, v32, v33
    v_cvt_pk_bf16_f32 v104, v34, v35
    v_lshlrev_b32 v98, 16, v96
    v_lshlrev_b32 v106, 16, v104
    v_and_b32 v99, 0xffff0000, v96
    s_waitcnt lgkmcnt(4)
    v_mfma_f32_32x32x16_bf16 v[80:95], v[20:23], a[0:3], 0
    ds_read_b64_tr_b16 v[16:17], v10 offset:4096
    ds_read_b64_tr_b16 v[18:19], v10 offset:4608
    v_and_b32 v107, 0xffff0000, v104
    v_mul_f32 v100, s46, v98
    v_mul_f32 v108, s46, v106
    v_mul_f32 v101, s47, v99
    v_mul_f32 v109, s47, v107
    s_waitcnt lgkmcnt(4)
    v_mfma_f32_32x32x16_bf16 v[64:79], v[24:27], a[4:7], v[64:79]
    ds_read_b64_tr_b16 v[20:21], v11 offset:4096
    ds_read_b64_tr_b16 v[22:23], v11 offset:4608
    v_add_f32 v102, s44, v98
    v_add_f32 v110, s44, v106
    v_add_f32 v103, s45, v99
    v_add_f32 v111, s45, v107
    v_exp_f32 v100, v100
    s_waitcnt lgkmcnt(4)
    v_mfma_f32_32x32x16_bf16 v[80:95], v[28:31], a[4:7], v[80:95]
    ds_read_b64_tr_b16 v[24:25], v10 offset:6144
    ds_read_b64_tr_b16 v[26:27], v10 offset:6656
    v_exp_f32 v108, v108
    v_exp_f32 v101, v101
    v_exp_f32 v109, v109
    v_cmp_lt_f32 vcc, 0, v98
    v_cmp_lt_f32 s[52:53], 0, v106
    s_waitcnt lgkmcnt(4)
    v_mfma_f32_32x32x16_bf16 v[64:79], v[16:19], a[8:11], v[64:79]
    ds_read_b64_tr_b16 v[28:29], v11 offset:6144
    ds_read_b64_tr_b16 v[30:31], v11 offset:6656
    v_cndmask_b32 v100, v100, v102, vcc
    v_cndmask_b32 v108, v108, v110, s[52:53]
    v_cmp_lt_f32 vcc, 0, v99
    v_cmp_lt_f32 s[52:53], 0, v107
    s_nop 0
    v_cndmask_b32 v101, v101, v103, vcc
    s_waitcnt lgkmcnt(4)
    v_mfma_f32_32x32x16_bf16 v[80:95], v[20:23], a[8:11], v[80:95]
    ds_read_b64_tr_b16 v[16:17], v10 offset:16512
    ds_read_b64_tr_b16 v[18:19], v10 offset:17024
    v_cndmask_b32 v109, v109, v111, s[52:53]
    v_cvt_pk_bf16_f32 v96, v100, v101
    v_cvt_pk_bf16_f32 v104, v108, v109
    v_lshlrev_b32 v100, 16, v96
    v_lshlrev_b32 v108, 16, v104
    s_waitcnt lgkmcnt(4)
    v_mfma_f32_32x32x16_bf16 v[64:79], v[24:27], a[12:15], v[64:79]
    ds_read_b64_tr_b16 v[20:21], v11 offset:16512
    ds_read_b64_tr_b16 v[22:23], v11 offset:17024
    v_and_b32 v101, 0xffff0000, v96
    v_and_b32 v109, 0xffff0000, v104
    v_add_f32 v100, s48, v100
    v_add_f32 v108, s48, v108
    v_add_f32 v101, s49, v101
    s_waitcnt lgkmcnt(4)
    v_mfma_f32_32x32x16_bf16 v[80:95], v[28:31], a[12:15], v[80:95]
    ds_read_b64_tr_b16 v[24:25], v10 offset:18560
    ds_read_b64_tr_b16 v[26:27], v10 offset:19072
    v_add_f32 v109, s49, v109
    v_cvt_pk_bf16_f32 v112, v100, v101
    v_cvt_pk_bf16_f32 v113, v108, v109
    v_cvt_pk_bf16_f32 v96, v36, v37
    v_cvt_pk_bf16_f32 v104, v38, v39
    s_waitcnt lgkmcnt(4)
    v_mfma_f32_32x32x16_bf16 v[64:79], v[16:19], a[16:19], v[64:79]
    ds_read_b64_tr_b16 v[28:29], v11 offset:18560
    ds_read_b64_tr_b16 v[30:31], v11 offset:19072
    v_lshlrev_b32 v98, 16, v96
    v_lshlrev_b32 v106, 16, v104
    v_and_b32 v99, 0xffff0000, v96
    v_and_b32 v107, 0xffff0000, v104
    v_mul_f32 v100, s46, v98
    s_waitcnt lgkmcnt(4)
    v_mfma_f32_32x32x16_bf16 v[80:95], v[20:23], a[16:19], v[80:95]
    ds_read_b64_tr_b16 v[16:17], v10 offset:20608
    ds_read_b64_tr_b16 v[18:19], v10 offset:21120
    v_mul_f32 v108, s46, v106
    v_mul_f32 v101, s47, v99
    v_mul_f32 v109, s47, v107
    v_add_f32 v102, s44, v98
    v_add_f32 v110, s44, v106
    s_waitcnt lgkmcnt(4)
    v_mfma_f32_32x32x16_bf16 v[64:79], v[24:27], a[20:23], v[64:79]
    ds_read_b64_tr_b16 v[20:21], v11 offset:20608
    ds_read_b64_tr_b16 v[22:23], v11 offset:21120
    v_add_f32 v103, s45, v99
    v_add_f32 v111, s45, v107
    v_exp_f32 v100, v100
    v_exp_f32 v108, v108
    v_exp_f32 v101, v101
    s_waitcnt lgkmcnt(4)
    v_mfma_f32_32x32x16_bf16 v[80:95], v[28:31], a[20:23], v[80:95]
    ds_read_b64_tr_b16 v[24:25], v10 offset:22656
    ds_read_b64_tr_b16 v[26:27], v10 offset:23168
    v_exp_f32 v109, v109
    v_cmp_lt_f32 vcc, 0, v98
    v_cmp_lt_f32 s[52:53], 0, v106
    s_nop 0
    v_cndmask_b32 v100, v100, v102, vcc
    v_cndmask_b32 v108, v108, v110, s[52:53]
    s_waitcnt lgkmcnt(4)
    v_mfma_f32_32x32x16_bf16 v[64:79], v[16:19], a[24:27], v[64:79]
    ds_read_b64_tr_b16 v[28:29], v11 offset:22656
    ds_read_b64_tr_b16 v[30:31], v11 offset:23168
    v_cmp_lt_f32 vcc, 0, v99
    v_cmp_lt_f32 s[52:53], 0, v107
    s_nop 0
    v_cndmask_b32 v101, v101, v103, vcc
    v_cndmask_b32 v109, v109, v111, s[52:53]
    v_cvt_pk_bf16_f32 v96, v100, v101
    s_waitcnt lgkmcnt(4)
    v_mfma_f32_32x32x16_bf16 v[80:95], v[20:23], a[24:27], v[80:95]
    ds_read_b64_tr_b16 v[16:17], v10 offset:33024
    ds_read_b64_tr_b16 v[18:19], v10 offset:33536
    v_cvt_pk_bf16_f32 v104, v108, v109
    v_lshlrev_b32 v100, 16, v96
    v_lshlrev_b32 v108, 16, v104
    v_and_b32 v101, 0xffff0000, v96
    v_and_b32 v109, 0xffff0000, v104
    s_waitcnt lgkmcnt(4)
    v_mfma_f32_32x32x16_bf16 v[64:79], v[24:27], a[28:31], v[64:79]
    ds_read_b64_tr_b16 v[20:21], v11 offset:33024
    ds_read_b64_tr_b16 v[22:23], v11 offset:33536
    v_add_f32 v100, s48, v100
    v_add_f32 v108, s48, v108
    v_add_f32 v101, s49, v101
    v_add_f32 v109, s49, v109
    v_cvt_pk_bf16_f32 v114, v100, v101
    s_waitcnt lgkmcnt(4)
    v_mfma_f32_32x32x16_bf16 v[80:95], v[28:31], a[28:31], v[80:95]
    ds_read_b64_tr_b16 v[24:25], v10 offset:35072
    ds_read_b64_tr_b16 v[26:27], v10 offset:35584
    v_cvt_pk_bf16_f32 v115, v108, v109
    buffer_store_dwordx4 v[112:115], v7, s[20:23], s30 offen offset:0 sc1
    v_cvt_pk_bf16_f32 v96, v40, v41
    v_cvt_pk_bf16_f32 v104, v42, v43
    v_lshlrev_b32 v98, 16, v96
    s_barrier
    s_lshl_b32 s54, s16, 6
    s_add_u32 s54, s54, 0
    s_lshl_b32 s55, s54, 6
    s_cmp_ge_u32 s54, 256
    s_cselect_b32 s56, 128, 0
    s_add_u32 s55, s55, s56
    s_mov_b32 m0, s55
    s_mul_i32 s54, s54, 3072
    buffer_load_dwordx4 v4, s[32:35], s54 offen lds
    s_lshl_b32 s54, s16, 6
    s_add_u32 s54, s54, 16
    s_lshl_b32 s55, s54, 6
    s_cmp_ge_u32 s54, 256
    s_cselect_b32 s56, 128, 0
    s_add_u32 s55, s55, s56
    s_mov_b32 m0, s55
    s_mul_i32 s54, s54, 3072
    buffer_load_dwordx4 v4, s[32:35], s54 offen lds
    s_lshl_b32 s54, s16, 6
    s_add_u32 s54, s54, 32
    s_lshl_b32 s55, s54, 6
    s_cmp_ge_u32 s54, 256
    s_cselect_b32 s56, 128, 0
    s_add_u32 s55, s55, s56
    s_mov_b32 m0, s55
    s_mul_i32 s54, s54, 3072
    buffer_load_dwordx4 v4, s[32:35], s54 offen lds
    s_lshl_b32 s54, s16, 6
    s_add_u32 s54, s54, 48
    s_lshl_b32 s55, s54, 6
    s_cmp_ge_u32 s54, 256
    s_cselect_b32 s56, 128, 0
    s_add_u32 s55, s55, s56
    s_mov_b32 m0, s55
    s_mul_i32 s54, s54, 3072
    buffer_load_dwordx4 v4, s[32:35], s54 offen lds
    s_waitcnt lgkmcnt(4)
    v_mfma_f32_32x32x16_bf16 v[64:79], v[16:19], a[32:35], v[64:79]
    ds_read_b64_tr_b16 v[28:29], v11 offset:35072
    ds_read_b64_tr_b16 v[30:31], v11 offset:35584
    v_lshlrev_b32 v106, 16, v104
    v_and_b32 v99, 0xffff0000, v96
    v_and_b32 v107, 0xffff0000, v104
    v_mul_f32 v100, s46, v98
    v_mul_f32 v108, s46, v106
    s_waitcnt lgkmcnt(4)
    v_mfma_f32_32x32x16_bf16 v[80:95], v[20:23], a[32:35], v[80:95]
    ds_read_b64_tr_b16 v[16:17], v10 offset:37120
    ds_read_b64_tr_b16 v[18:19], v10 offset:37632
    v_mul_f32 v101, s47, v99
    v_mul_f32 v109, s47, v107
    v_add_f32 v102, s44, v98
    v_add_f32 v110, s44, v106
    v_add_f32 v103, s45, v99
    s_waitcnt lgkmcnt(4)
    v_mfma_f32_32x32x16_bf16 v[64:79], v[24:27], a[36:39], v[64:79]
    ds_read_b64_tr_b16 v[20:21], v11 offset:37120
    ds_read_b64_tr_b16 v[22:23], v11 offset:37632
    v_add_f32 v111, s45, v107
    v_exp_f32 v100, v100
    v_exp_f32 v108, v108
    v_exp_f32 v101, v101
    v_exp_f32 v109, v109
    s_waitcnt lgkmcnt(4)
    v_mfma_f32_32x32x16_bf16 v[80:95], v[28:31], a[36:39], v[80:95]
    ds_read_b64_tr_b16 v[24:25], v10 offset:39168
    ds_read_b64_tr_b16 v[26:27], v10 offset:39680
    v_cmp_lt_f32 vcc, 0, v98
    v_cmp_lt_f32 s[52:53], 0, v106
    s_nop 0
    v_cndmask_b32 v100, v100, v102, vcc
    v_cndmask_b32 v108, v108, v110, s[52:53]
    v_cmp_lt_f32 vcc, 0, v99
    s_waitcnt lgkmcnt(4)
    v_mfma_f32_32x32x16_bf16 v[64:79], v[16:19], a[40:43], v[64:79]
    ds_read_b64_tr_b16 v[28:29], v11 offset:39168
    ds_read_b64_tr_b16 v[30:31], v11 offset:39680
    v_cmp_lt_f32 s[52:53], 0, v107
    v_cndmask_b32 v101, v101, v103, vcc
    s_nop 0
    v_cndmask_b32 v109, v109, v111, s[52:53]
    v_cvt_pk_bf16_f32 v96, v100, v101
    v_cvt_pk_bf16_f32 v104, v108, v109
    s_waitcnt lgkmcnt(4)
    v_mfma_f32_32x32x16_bf16 v[80:95], v[20:23], a[40:43], v[80:95]
    ds_read_b64_tr_b16 v[16:17], v10 offset:49536
    ds_read_b64_tr_b16 v[18:19], v10 offset:50048
    v_lshlrev_b32 v100, 16, v96
    v_lshlrev_b32 v108, 16, v104
    v_and_b32 v101, 0xffff0000, v96
    v_and_b32 v109, 0xffff0000, v104
    v_add_f32 v100, s48, v100
    s_waitcnt lgkmcnt(4)
    v_mfma_f32_32x32x16_bf16 v[64:79], v[24:27], a[44:47], v[64:79]
    ds_read_b64_tr_b16 v[20:21], v11 offset:49536
    ds_read_b64_tr_b16 v[22:23], v11 offset:50048
    v_add_f32 v108, s48, v108
    v_add_f32 v101, s49, v101
    v_add_f32 v109, s49, v109
    v_cvt_pk_bf16_f32 v116, v100, v101
    v_cvt_pk_bf16_f32 v117, v108, v109
    s_waitcnt lgkmcnt(4)
    v_mfma_f32_32x32x16_bf16 v[80:95], v[28:31], a[44:47], v[80:95]
    ds_read_b64_tr_b16 v[24:25], v10 offset:51584
    ds_read_b64_tr_b16 v[26:27], v10 offset:52096
    v_cvt_pk_bf16_f32 v96, v44, v45
    v_cvt_pk_bf16_f32 v104, v46, v47
    v_lshlrev_b32 v98, 16, v96
    v_lshlrev_b32 v106, 16, v104
    v_and_b32 v99, 0xffff0000, v96
    s_waitcnt lgkmcnt(4)
    v_mfma_f32_32x32x16_bf16 v[64:79], v[16:19], a[48:51], v[64:79]
    ds_read_b64_tr_b16 v[28:29], v11 offset:51584
    ds_read_b64_tr_b16 v[30:31], v11 offset:52096
    v_and_b32 v107, 0xffff0000, v104
    v_mul_f32 v100, s46, v98
    v_mul_f32 v108, s46, v106
    v_mul_f32 v101, s47, v99
    v_mul_f32 v109, s47, v107
    s_waitcnt lgkmcnt(4)
    v_mfma_f32_32x32x16_bf16 v[80:95], v[20:23], a[48:51], v[80:95]
    ds_read_b64_tr_b16 v[16:17], v10 offset:53632
    ds_read_b64_tr_b16 v[18:19], v10 offset:54144
    v_add_f32 v102, s44, v98
    v_add_f32 v110, s44, v106
    v_add_f32 v103, s45, v99
    v_add_f32 v111, s45, v107
    v_exp_f32 v100, v100
    s_waitcnt lgkmcnt(4)
    v_mfma_f32_32x32x16_bf16 v[64:79], v[24:27], a[52:55], v[64:79]
    ds_read_b64_tr_b16 v[20:21], v11 offset:53632
    ds_read_b64_tr_b16 v[22:23], v11 offset:54144
    v_exp_f32 v108, v108
    v_exp_f32 v101, v101
    v_exp_f32 v109, v109
    v_cmp_lt_f32 vcc, 0, v98
    v_cmp_lt_f32 s[52:53], 0, v106
    s_waitcnt lgkmcnt(4)
    v_mfma_f32_32x32x16_bf16 v[80:95], v[28:31], a[52:55], v[80:95]
    ds_read_b64_tr_b16 v[24:25], v10 offset:55680
    ds_read_b64_tr_b16 v[26:27], v10 offset:56192
    v_cndmask_b32 v100, v100, v102, vcc
    v_cndmask_b32 v108, v108, v110, s[52:53]
    v_cmp_lt_f32 vcc, 0, v99
    v_cmp_lt_f32 s[52:53], 0, v107
    s_nop 0
    v_cndmask_b32 v101, v101, v103, vcc
    s_waitcnt lgkmcnt(4)
    v_mfma_f32_32x32x16_bf16 v[64:79], v[16:19], a[56:59], v[64:79]
    ds_read_b64_tr_b16 v[28:29], v11 offset:55680
    ds_read_b64_tr_b16 v[30:31], v11 offset:56192
    v_cndmask_b32 v109, v109, v111, s[52:53]
    v_cvt_pk_bf16_f32 v96, v100, v101
    v_cvt_pk_bf16_f32 v104, v108, v109
    v_lshlrev_b32 v100, 16, v96
    v_lshlrev_b32 v108, 16, v104
    s_waitcnt lgkmcnt(4)
    v_mfma_f32_32x32x16_bf16 v[80:95], v[20:23], a[56:59], v[80:95]
    ds_read_b64_tr_b16 v[16:17], v14 offset:0
    ds_read_b64_tr_b16 v[18:19], v14 offset:512
    v_and_b32 v101, 0xffff0000, v96
    v_and_b32 v109, 0xffff0000, v104
    v_add_f32 v100, s48, v100
    v_add_f32 v108, s48, v108
    v_add_f32 v101, s49, v101
    s_waitcnt lgkmcnt(4)
    v_mfma_f32_32x32x16_bf16 v[64:79], v[24:27], a[60:63], v[64:79]
    ds_read_b64_tr_b16 v[20:21], v15 offset:0
    ds_read_b64_tr_b16 v[22:23], v15 offset:512
    v_add_f32 v109, s49, v109
    v_cvt_pk_bf16_f32 v118, v100, v101
    v_cvt_pk_bf16_f32 v119, v108, v109
    buffer_store_dwordx4 v[116:119], v7, s[20:23], s29 offen offset:0 sc1
    v_cvt_pk_bf16_f32 v96, v48, v49
    s_waitcnt lgkmcnt(4)
    v_mfma_f32_32x32x16_bf16 v[80:95], v[28:31], a[60:63], v[80:95]
    ds_read_b64_tr_b16 v[24:25], v14 offset:2048
    ds_read_b64_tr_b16 v[26:27], v14 offset:2560
    v_cvt_pk_bf16_f32 v104, v50, v51
    v_lshlrev_b32 v98, 16, v96
    v_lshlrev_b32 v106, 16, v104
    v_and_b32 v99, 0xffff0000, v96
    v_and_b32 v107, 0xffff0000, v104
    s_waitcnt lgkmcnt(4)
    v_mfma_f32_32x32x16_bf16 v[64:79], v[16:19], a[64:67], v[64:79]
    ds_read_b64_tr_b16 v[28:29], v15 offset:2048
    ds_read_b64_tr_b16 v[30:31], v15 offset:2560
    v_mul_f32 v100, s46, v98
    v_mul_f32 v108, s46, v106
    v_mul_f32 v101, s47, v99
    v_mul_f32 v109, s47, v107
    v_add_f32 v102, s44, v98
    s_waitcnt lgkmcnt(4)
    v_mfma_f32_32x32x16_bf16 v[80:95], v[20:23], a[64:67], v[80:95]
    ds_read_b64_tr_b16 v[16:17], v14 offset:4096
    ds_read_b64_tr_b16 v[18:19], v14 offset:4608
    v_add_f32 v110, s44, v106
    v_add_f32 v103, s45, v99
    v_add_f32 v111, s45, v107
    v_exp_f32 v100, v100
    v_exp_f32 v108, v108
    s_waitcnt lgkmcnt(4)
    v_mfma_f32_32x32x16_bf16 v[64:79], v[24:27], a[68:71], v[64:79]
    ds_read_b64_tr_b16 v[20:21], v15 offset:4096
    ds_read_b64_tr_b16 v[22:23], v15 offset:4608
    v_exp_f32 v101, v101
    v_exp_f32 v109, v109
    v_cmp_lt_f32 vcc, 0, v98
    v_cmp_lt_f32 s[52:53], 0, v106
    s_nop 0
    v_cndmask_b32 v100, v100, v102, vcc
    s_waitcnt lgkmcnt(4)
    v_mfma_f32_32x32x16_bf16 v[80:95], v[28:31], a[68:71], v[80:95]
    ds_read_b64_tr_b16 v[24:25], v14 offset:6144
    ds_read_b64_tr_b16 v[26:27], v14 offset:6656
    v_cndmask_b32 v108, v108, v110, s[52:53]
    v_cmp_lt_f32 vcc, 0, v99
    v_cmp_lt_f32 s[52:53], 0, v107
    s_nop 0
    v_cndmask_b32 v101, v101, v103, vcc
    v_cndmask_b32 v109, v109, v111, s[52:53]
    s_waitcnt lgkmcnt(4)
    v_mfma_f32_32x32x16_bf16 v[64:79], v[16:19], a[72:75], v[64:79]
    ds_read_b64_tr_b16 v[28:29], v15 offset:6144
    ds_read_b64_tr_b16 v[30:31], v15 offset:6656
    v_cvt_pk_bf16_f32 v96, v100, v101
    v_cvt_pk_bf16_f32 v104, v108, v109
    v_lshlrev_b32 v100, 16, v96
    v_lshlrev_b32 v108, 16, v104
    v_and_b32 v101, 0xffff0000, v96
    s_waitcnt lgkmcnt(4)
    v_mfma_f32_32x32x16_bf16 v[80:95], v[20:23], a[72:75], v[80:95]
    ds_read_b64_tr_b16 v[16:17], v14 offset:16512
    ds_read_b64_tr_b16 v[18:19], v14 offset:17024
    v_and_b32 v109, 0xffff0000, v104
    v_add_f32 v100, s48, v100
    v_add_f32 v108, s48, v108
    v_add_f32 v101, s49, v101
    v_add_f32 v109, s49, v109
    s_waitcnt lgkmcnt(4)
    v_mfma_f32_32x32x16_bf16 v[64:79], v[24:27], a[76:79], v[64:79]
    ds_read_b64_tr_b16 v[20:21], v15 offset:16512
    ds_read_b64_tr_b16 v[22:23], v15 offset:17024
    v_cvt_pk_bf16_f32 v112, v100, v101
    v_cvt_pk_bf16_f32 v113, v108, v109
    v_cvt_pk_bf16_f32 v96, v52, v53
    v_cvt_pk_bf16_f32 v104, v54, v55
    v_lshlrev_b32 v98, 16, v96
    s_waitcnt lgkmcnt(4)
    v_mfma_f32_32x32x16_bf16 v[80:95], v[28:31], a[76:79], v[80:95]
    ds_read_b64_tr_b16 v[24:25], v14 offset:18560
    ds_read_b64_tr_b16 v[26:27], v14 offset:19072
    v_lshlrev_b32 v106, 16, v104
    v_and_b32 v99, 0xffff0000, v96
    v_and_b32 v107, 0xffff0000, v104
    v_mul_f32 v100, s46, v98
    v_mul_f32 v108, s46, v106
    s_waitcnt lgkmcnt(4)
    v_mfma_f32_32x32x16_bf16 v[64:79], v[16:19], a[80:83], v[64:79]
    ds_read_b64_tr_b16 v[28:29], v15 offset:18560
    ds_read_b64_tr_b16 v[30:31], v15 offset:19072
    v_mul_f32 v101, s47, v99
    v_mul_f32 v109, s47, v107
    v_add_f32 v102, s44, v98
    v_add_f32 v110, s44, v106
    v_add_f32 v103, s45, v99
    s_waitcnt lgkmcnt(4)
    v_mfma_f32_32x32x16_bf16 v[80:95], v[20:23], a[80:83], v[80:95]
    ds_read_b64_tr_b16 v[16:17], v14 offset:20608
    ds_read_b64_tr_b16 v[18:19], v14 offset:21120
    v_add_f32 v111, s45, v107
    v_exp_f32 v100, v100
    v_exp_f32 v108, v108
    v_exp_f32 v101, v101
    v_exp_f32 v109, v109
    s_waitcnt lgkmcnt(4)
    v_mfma_f32_32x32x16_bf16 v[64:79], v[24:27], a[84:87], v[64:79]
    ds_read_b64_tr_b16 v[20:21], v15 offset:20608
    ds_read_b64_tr_b16 v[22:23], v15 offset:21120
    v_cmp_lt_f32 vcc, 0, v98
    v_cmp_lt_f32 s[52:53], 0, v106
    s_nop 0
    v_cndmask_b32 v100, v100, v102, vcc
    v_cndmask_b32 v108, v108, v110, s[52:53]
    v_cmp_lt_f32 vcc, 0, v99
    s_waitcnt lgkmcnt(4)
    v_mfma_f32_32x32x16_bf16 v[80:95], v[28:31], a[84:87], v[80:95]
    ds_read_b64_tr_b16 v[24:25], v14 offset:22656
    ds_read_b64_tr_b16 v[26:27], v14 offset:23168
    v_cmp_lt_f32 s[52:53], 0, v107
    v_cndmask_b32 v101, v101, v103, vcc
    s_nop 0
    v_cndmask_b32 v109, v109, v111, s[52:53]
    v_cvt_pk_bf16_f32 v96, v100, v101
    v_cvt_pk_bf16_f32 v104, v108, v109
    s_waitcnt lgkmcnt(4)
    v_mfma_f32_32x32x16_bf16 v[64:79], v[16:19], a[88:91], v[64:79]
    ds_read_b64_tr_b16 v[28:29], v15 offset:22656
    ds_read_b64_tr_b16 v[30:31], v15 offset:23168
    v_lshlrev_b32 v100, 16, v96
    v_lshlrev_b32 v108, 16, v104
    v_and_b32 v101, 0xffff0000, v96
    v_and_b32 v109, 0xffff0000, v104
    v_add_f32 v100, s48, v100
    s_waitcnt lgkmcnt(4)
    v_mfma_f32_32x32x16_bf16 v[80:95], v[20:23], a[88:91], v[80:95]
    ds_read_b64_tr_b16 v[16:17], v14 offset:33024
    ds_read_b64_tr_b16 v[18:19], v14 offset:33536
    v_add_f32 v108, s48, v108
    v_add_f32 v101, s49, v101
    v_add_f32 v109, s49, v109
    v_cvt_pk_bf16_f32 v114, v100, v101
    v_cvt_pk_bf16_f32 v115, v108, v109
    s_waitcnt lgkmcnt(4)
    v_mfma_f32_32x32x16_bf16 v[64:79], v[24:27], a[92:95], v[64:79]
    ds_read_b64_tr_b16 v[20:21], v15 offset:33024
    ds_read_b64_tr_b16 v[22:23], v15 offset:33536
    buffer_store_dwordx4 v[112:115], v7, s[20:23], s30 offen offset:1024 sc1
    v_cvt_pk_bf16_f32 v96, v56, v57
    v_cvt_pk_bf16_f32 v104, v58, v59
    v_lshlrev_b32 v98, 16, v96
    v_lshlrev_b32 v106, 16, v104
    s_waitcnt lgkmcnt(4)
    v_mfma_f32_32x32x16_bf16 v[80:95], v[28:31], a[92:95], v[80:95]
    ds_read_b64_tr_b16 v[24:25], v14 offset:35072
    ds_read_b64_tr_b16 v[26:27], v14 offset:35584
    v_and_b32 v99, 0xffff0000, v96
    v_and_b32 v107, 0xffff0000, v104
    v_mul_f32 v100, s46, v98
    v_mul_f32 v108, s46, v106
    v_mul_f32 v101, s47, v99
    s_waitcnt lgkmcnt(4)
    v_mfma_f32_32x32x16_bf16 v[64:79], v[16:19], a[96:99], v[64:79]
    ds_read_b64_tr_b16 v[28:29], v15 offset:35072
    ds_read_b64_tr_b16 v[30:31], v15 offset:35584
    v_mul_f32 v109, s47, v107
    v_add_f32 v102, s44, v98
    v_add_f32 v110, s44, v106
    v_add_f32 v103, s45, v99
    v_add_f32 v111, s45, v107
    s_waitcnt lgkmcnt(4)
    v_mfma_f32_32x32x16_bf16 v[80:95], v[20:23], a[96:99], v[80:95]
    ds_read_b64_tr_b16 v[16:17], v14 offset:37120
    ds_read_b64_tr_b16 v[18:19], v14 offset:37632
    v_exp_f32 v100, v100
    v_exp_f32 v108, v108
    v_exp_f32 v101, v101
    v_exp_f32 v109, v109
    v_cmp_lt_f32 vcc, 0, v98
    s_waitcnt lgkmcnt(4)
    v_mfma_f32_32x32x16_bf16 v[64:79], v[24:27], a[100:103], v[64:79]
    ds_read_b64_tr_b16 v[20:21], v15 offset:37120
    ds_read_b64_tr_b16 v[22:23], v15 offset:37632
    v_cmp_lt_f32 s[52:53], 0, v106
    v_cndmask_b32 v100, v100, v102, vcc
    s_nop 0
    v_cndmask_b32 v108, v108, v110, s[52:53]
    v_cmp_lt_f32 vcc, 0, v99
    v_cmp_lt_f32 s[52:53], 0, v107
    s_waitcnt lgkmcnt(4)
    v_mfma_f32_32x32x16_bf16 v[80:95], v[28:31], a[100:103], v[80:95]
    ds_read_b64_tr_b16 v[24:25], v14 offset:39168
    ds_read_b64_tr_b16 v[26:27], v14 offset:39680
    v_cndmask_b32 v101, v101, v103, vcc
    v_cndmask_b32 v109, v109, v111, s[52:53]
    v_cvt_pk_bf16_f32 v96, v100, v101
    v_cvt_pk_bf16_f32 v104, v108, v109
    v_lshlrev_b32 v100, 16, v96
    s_waitcnt lgkmcnt(4)
    v_mfma_f32_32x32x16_bf16 v[64:79], v[16:19], a[104:107], v[64:79]
    ds_read_b64_tr_b16 v[28:29], v15 offset:39168
    ds_read_b64_tr_b16 v[30:31], v15 offset:39680
    v_lshlrev_b32 v108, 16, v104
    v_and_b32 v101, 0xffff0000, v96
    v_and_b32 v109, 0xffff0000, v104
    v_add_f32 v100, s48, v100
    v_add_f32 v108, s48, v108
    s_waitcnt lgkmcnt(4)
    v_mfma_f32_32x32x16_bf16 v[80:95], v[20:23], a[104:107], v[80:95]
    ds_read_b64_tr_b16 v[16:17], v14 offset:49536
    ds_read_b64_tr_b16 v[18:19], v14 offset:50048
    v_add_f32 v101, s49, v101
    v_add_f32 v109, s49, v109
    v_cvt_pk_bf16_f32 v116, v100, v101
    v_cvt_pk_bf16_f32 v117, v108, v109
    v_cvt_pk_bf16_f32 v96, v60, v61
    s_waitcnt lgkmcnt(4)
    v_mfma_f32_32x32x16_bf16 v[64:79], v[24:27], a[108:111], v[64:79]
    ds_read_b64_tr_b16 v[20:21], v15 offset:49536
    ds_read_b64_tr_b16 v[22:23], v15 offset:50048
    v_cvt_pk_bf16_f32 v104, v62, v63
    v_lshlrev_b32 v98, 16, v96
    v_lshlrev_b32 v106, 16, v104
    v_and_b32 v99, 0xffff0000, v96
    v_and_b32 v107, 0xffff0000, v104
    s_waitcnt lgkmcnt(4)
    v_mfma_f32_32x32x16_bf16 v[80:95], v[28:31], a[108:111], v[80:95]
    ds_read_b64_tr_b16 v[24:25], v14 offset:51584
    ds_read_b64_tr_b16 v[26:27], v14 offset:52096
    v_mul_f32 v100, s46, v98
    v_mul_f32 v108, s46, v106
    v_mul_f32 v101, s47, v99
    v_mul_f32 v109, s47, v107
    v_add_f32 v102, s44, v98
    s_waitcnt lgkmcnt(4)
    v_mfma_f32_32x32x16_bf16 v[64:79], v[16:19], a[112:115], v[64:79]
    ds_read_b64_tr_b16 v[28:29], v15 offset:51584
    ds_read_b64_tr_b16 v[30:31], v15 offset:52096
    v_add_f32 v110, s44, v106
    v_add_f32 v103, s45, v99
    v_add_f32 v111, s45, v107
    v_exp_f32 v100, v100
    v_exp_f32 v108, v108
    s_waitcnt lgkmcnt(4)
    v_mfma_f32_32x32x16_bf16 v[80:95], v[20:23], a[112:115], v[80:95]
    ds_read_b64_tr_b16 v[16:17], v14 offset:53632
    ds_read_b64_tr_b16 v[18:19], v14 offset:54144
    v_exp_f32 v101, v101
    v_exp_f32 v109, v109
    v_cmp_lt_f32 vcc, 0, v98
    v_cmp_lt_f32 s[52:53], 0, v106
    s_nop 0
    v_cndmask_b32 v100, v100, v102, vcc
    s_waitcnt lgkmcnt(4)
    v_mfma_f32_32x32x16_bf16 v[64:79], v[24:27], a[116:119], v[64:79]
    ds_read_b64_tr_b16 v[20:21], v15 offset:53632
    ds_read_b64_tr_b16 v[22:23], v15 offset:54144
    v_cndmask_b32 v108, v108, v110, s[52:53]
    v_cmp_lt_f32 vcc, 0, v99
    v_cmp_lt_f32 s[52:53], 0, v107
    s_nop 0
    v_cndmask_b32 v101, v101, v103, vcc
    v_cndmask_b32 v109, v109, v111, s[52:53]
    s_waitcnt lgkmcnt(4)
    v_mfma_f32_32x32x16_bf16 v[80:95], v[28:31], a[116:119], v[80:95]
    ds_read_b64_tr_b16 v[24:25], v14 offset:55680
    ds_read_b64_tr_b16 v[26:27], v14 offset:56192
    v_cvt_pk_bf16_f32 v96, v100, v101
    v_cvt_pk_bf16_f32 v104, v108, v109
    v_lshlrev_b32 v100, 16, v96
    v_lshlrev_b32 v108, 16, v104
    v_and_b32 v101, 0xffff0000, v96
    s_waitcnt lgkmcnt(4)
    v_mfma_f32_32x32x16_bf16 v[64:79], v[16:19], a[120:123], v[64:79]
    ds_read_b64_tr_b16 v[28:29], v15 offset:55680
    ds_read_b64_tr_b16 v[30:31], v15 offset:56192
    v_and_b32 v109, 0xffff0000, v104
    v_add_f32 v100, s48, v100
    v_add_f32 v108, s48, v108
    v_add_f32 v101, s49, v101
    v_add_f32 v109, s49, v109
    s_waitcnt lgkmcnt(4)
    v_mfma_f32_32x32x16_bf16 v[80:95], v[20:23], a[120:123], v[80:95]
    v_cvt_pk_bf16_f32 v118, v100, v101
    v_cvt_pk_bf16_f32 v119, v108, v109
    buffer_store_dwordx4 v[116:119], v7, s[20:23], s29 offen offset:1024 sc1
    s_waitcnt lgkmcnt(2)
    v_mfma_f32_32x32x16_bf16 v[64:79], v[24:27], a[124:127], v[64:79]
    s_waitcnt lgkmcnt(0)
    v_mfma_f32_32x32x16_bf16 v[80:95], v[28:31], a[124:127], v[80:95]
    s_waitcnt vmcnt(0)
    s_barrier
    ds_read_b64_tr_b16 v[16:17], v6 offset:0
    ds_read_b64_tr_b16 v[18:19], v6 offset:256
    ds_read_b64_tr_b16 v[20:21], v6 offset:1024
    ds_read_b64_tr_b16 v[22:23], v6 offset:1280
    ds_read_b64_tr_b16 v[24:25], v6 offset:2048
    ds_read_b64_tr_b16 v[26:27], v6 offset:2304
    s_waitcnt lgkmcnt(4)
    v_mfma_f32_32x32x16_bf16 v[112:127], a[0:3], v[16:19], 0
    ds_read_b64_tr_b16 v[28:29], v6 offset:3072
    ds_read_b64_tr_b16 v[30:31], v6 offset:3328
    v_cvt_pk_bf16_f32 v96, v64, v65
    v_cvt_pk_bf16_f32 v104, v66, v67
    v_lshlrev_b32 v98, 16, v96
    v_lshlrev_b32 v106, 16, v104
    v_and_b32 v99, 0xffff0000, v96
    v_and_b32 v107, 0xffff0000, v104
    v_mul_f32 v100, s46, v98
    v_mul_f32 v108, s46, v106
    v_mul_f32 v101, s47, v99
    v_mul_f32 v109, s47, v107
    s_waitcnt lgkmcnt(4)
    v_mfma_f32_32x32x16_bf16 v[112:127], a[4:7], v[20:23], v[112:127]
    ds_read_b64_tr_b16 v[16:17], v6 offset:4096
    ds_read_b64_tr_b16 v[18:19], v6 offset:4352
    v_add_f32 v102, s44, v98
    v_add_f32 v110, s44, v106
    v_add_f32 v103, s45, v99
    v_add_f32 v111, s45, v107
    v_exp_f32 v100, v100
    v_exp_f32 v108, v108
    v_exp_f32 v101, v101
    v_exp_f32 v109, v109
    v_cmp_lt_f32 vcc, 0, v98
    v_cmp_lt_f32 s[52:53], 0, v106
    s_waitcnt lgkmcnt(4)
    v_mfma_f32_32x32x16_bf16 v[112:127], a[8:11], v[24:27], v[112:127]
    ds_read_b64_tr_b16 v[20:21], v6 offset:5120
    ds_read_b64_tr_b16 v[22:23], v6 offset:5376
    v_cndmask_b32 v100, v100, v102, vcc
    v_cndmask_b32 v108, v108, v110, s[52:53]
    v_cmp_lt_f32 vcc, 0, v99
    v_cmp_lt_f32 s[52:53], 0, v107
    s_nop 0
    v_cndmask_b32 v101, v101, v103, vcc
    v_cndmask_b32 v109, v109, v111, s[52:53]
    v_cvt_pk_bf16_f32 v96, v100, v101
    v_cvt_pk_bf16_f32 v104, v108, v109
    v_lshlrev_b32 v100, 16, v96
    v_lshlrev_b32 v108, 16, v104
    s_waitcnt lgkmcnt(4)
    v_mfma_f32_32x32x16_bf16 v[112:127], a[12:15], v[28:31], v[112:127]
    ds_read_b64_tr_b16 v[24:25], v6 offset:6144
    ds_read_b64_tr_b16 v[26:27], v6 offset:6400
    v_and_b32 v101, 0xffff0000, v96
    v_and_b32 v109, 0xffff0000, v104
    v_add_f32 v100, s48, v100
    v_add_f32 v108, s48, v108
    v_add_f32 v101, s49, v101
    v_add_f32 v109, s49, v109
    v_cvt_pk_bf16_f32 v8, v100, v101
    v_cvt_pk_bf16_f32 v9, v108, v109
    v_cvt_pk_bf16_f32 v96, v68, v69
    v_cvt_pk_bf16_f32 v104, v70, v71
    s_waitcnt lgkmcnt(4)
    v_mfma_f32_32x32x16_bf16 v[112:127], a[16:19], v[16:19], v[112:127]
    ds_read_b64_tr_b16 v[28:29], v6 offset:7168
    ds_read_b64_tr_b16 v[30:31], v6 offset:7424
    v_lshlrev_b32 v98, 16, v96
    v_lshlrev_b32 v106, 16, v104
    v_and_b32 v99, 0xffff0000, v96
    v_and_b32 v107, 0xffff0000, v104
    v_mul_f32 v100, s46, v98
    v_mul_f32 v108, s46, v106
    v_mul_f32 v101, s47, v99
    v_mul_f32 v109, s47, v107
    v_add_f32 v102, s44, v98
    v_add_f32 v110, s44, v106
    s_waitcnt lgkmcnt(4)
    v_mfma_f32_32x32x16_bf16 v[112:127], a[20:23], v[20:23], v[112:127]
    ds_read_b64_tr_b16 v[16:17], v6 offset:8192
    ds_read_b64_tr_b16 v[18:19], v6 offset:8448
    v_add_f32 v103, s45, v99
    v_add_f32 v111, s45, v107
    v_exp_f32 v100, v100
    v_exp_f32 v108, v108
    v_exp_f32 v101, v101
    v_exp_f32 v109, v109
    v_cmp_lt_f32 vcc, 0, v98
    v_cmp_lt_f32 s[52:53], 0, v106
    s_nop 0
    v_cndmask_b32 v100, v100, v102, vcc
    v_cndmask_b32 v108, v108, v110, s[52:53]
    s_waitcnt lgkmcnt(4)
    v_mfma_f32_32x32x16_bf16 v[112:127], a[24:27], v[24:27], v[112:127]
    ds_read_b64_tr_b16 v[20:21], v6 offset:9216
    ds_read_b64_tr_b16 v[22:23], v6 offset:9472
    v_cmp_lt_f32 vcc, 0, v99
    v_cmp_lt_f32 s[52:53], 0, v107
    s_nop 0
    v_cndmask_b32 v101, v101, v103, vcc
    v_cndmask_b32 v109, v109, v111, s[52:53]
    v_cvt_pk_bf16_f32 v96, v100, v101
    v_cvt_pk_bf16_f32 v104, v108, v109
    v_lshlrev_b32 v100, 16, v96
    v_lshlrev_b32 v108, 16, v104
    v_and_b32 v101, 0xffff0000, v96
    v_and_b32 v109, 0xffff0000, v104
    s_waitcnt lgkmcnt(4)
    v_mfma_f32_32x32x16_bf16 v[112:127], a[28:31], v[28:31], v[112:127]
    ds_read_b64_tr_b16 v[24:25], v6 offset:10240
    ds_read_b64_tr_b16 v[26:27], v6 offset:10496
    v_add_f32 v100, s48, v100
    v_add_f32 v108, s48, v108
    v_add_f32 v101, s49, v101
    v_add_f32 v109, s49, v109
    v_cvt_pk_bf16_f32 v10, v100, v101
    v_cvt_pk_bf16_f32 v11, v108, v109
    buffer_store_dwordx4 v[8:11], v7, s[20:23], s30 offen offset:2048 sc1
    v_cvt_pk_bf16_f32 v96, v72, v73
    v_cvt_pk_bf16_f32 v104, v74, v75
    v_lshlrev_b32 v98, 16, v96
    s_waitcnt lgkmcnt(4)
    v_mfma_f32_32x32x16_bf16 v[112:127], a[32:35], v[16:19], v[112:127]
    ds_read_b64_tr_b16 v[28:29], v6 offset:11264
    ds_read_b64_tr_b16 v[30:31], v6 offset:11520
    v_lshlrev_b32 v106, 16, v104
    v_and_b32 v99, 0xffff0000, v96
    v_and_b32 v107, 0xffff0000, v104
    v_mul_f32 v100, s46, v98
    v_mul_f32 v108, s46, v106
    v_mul_f32 v101, s47, v99
    v_mul_f32 v109, s47, v107
    v_add_f32 v102, s44, v98
    v_add_f32 v110, s44, v106
    v_add_f32 v103, s45, v99
    s_waitcnt lgkmcnt(4)
    v_mfma_f32_32x32x16_bf16 v[112:127], a[36:39], v[20:23], v[112:127]
    ds_read_b64_tr_b16 v[16:17], v6 offset:12288
    ds_read_b64_tr_b16 v[18:19], v6 offset:12544
    v_add_f32 v111, s45, v107
    v_exp_f32 v100, v100
    v_exp_f32 v108, v108
    v_exp_f32 v101, v101
    v_exp_f32 v109, v109
    v_cmp_lt_f32 vcc, 0, v98
    v_cmp_lt_f32 s[52:53], 0, v106
    s_nop 0
    v_cndmask_b32 v100, v100, v102, vcc
    v_cndmask_b32 v108, v108, v110, s[52:53]
    v_cmp_lt_f32 vcc, 0, v99
    s_waitcnt lgkmcnt(4)
    v_mfma_f32_32x32x16_bf16 v[112:127], a[40:43], v[24:27], v[112:127]
    ds_read_b64_tr_b16 v[20:21], v6 offset:13312
    ds_read_b64_tr_b16 v[22:23], v6 offset:13568
    v_cmp_lt_f32 s[52:53], 0, v107
    v_cndmask_b32 v101, v101, v103, vcc
    s_nop 0
    v_cndmask_b32 v109, v109, v111, s[52:53]
    v_cvt_pk_bf16_f32 v96, v100, v101
    v_cvt_pk_bf16_f32 v104, v108, v109
    v_lshlrev_b32 v100, 16, v96
    v_lshlrev_b32 v108, 16, v104
    v_and_b32 v101, 0xffff0000, v96
    v_and_b32 v109, 0xffff0000, v104
    v_add_f32 v100, s48, v100
    s_waitcnt lgkmcnt(4)
    v_mfma_f32_32x32x16_bf16 v[112:127], a[44:47], v[28:31], v[112:127]
    ds_read_b64_tr_b16 v[24:25], v6 offset:14336
    ds_read_b64_tr_b16 v[26:27], v6 offset:14592
    v_add_f32 v108, s48, v108
    v_add_f32 v101, s49, v101
    v_add_f32 v109, s49, v109
    v_cvt_pk_bf16_f32 v12, v100, v101
    v_cvt_pk_bf16_f32 v13, v108, v109
    v_cvt_pk_bf16_f32 v96, v76, v77
    v_cvt_pk_bf16_f32 v104, v78, v79
    v_lshlrev_b32 v98, 16, v96
    v_lshlrev_b32 v106, 16, v104
    v_and_b32 v99, 0xffff0000, v96
    s_waitcnt lgkmcnt(4)
    v_mfma_f32_32x32x16_bf16 v[112:127], a[48:51], v[16:19], v[112:127]
    ds_read_b64_tr_b16 v[28:29], v6 offset:15360
    ds_read_b64_tr_b16 v[30:31], v6 offset:15616
    v_and_b32 v107, 0xffff0000, v104
    v_mul_f32 v100, s46, v98
    v_mul_f32 v108, s46, v106
    v_mul_f32 v101, s47, v99
    v_mul_f32 v109, s47, v107
    v_add_f32 v102, s44, v98
    v_add_f32 v110, s44, v106
    v_add_f32 v103, s45, v99
    v_add_f32 v111, s45, v107
    v_exp_f32 v100, v100
    s_waitcnt lgkmcnt(4)
    v_mfma_f32_32x32x16_bf16 v[112:127], a[52:55], v[20:23], v[112:127]
    ds_read_b64_tr_b16 v[16:17], v6 offset:16512
    ds_read_b64_tr_b16 v[18:19], v6 offset:16768
    v_exp_f32 v108, v108
    v_exp_f32 v101, v101
    v_exp_f32 v109, v109
    v_cmp_lt_f32 vcc, 0, v98
    v_cmp_lt_f32 s[52:53], 0, v106
    s_nop 0
    v_cndmask_b32 v100, v100, v102, vcc
    v_cndmask_b32 v108, v108, v110, s[52:53]
    v_cmp_lt_f32 vcc, 0, v99
    v_cmp_lt_f32 s[52:53], 0, v107
    s_nop 0
    v_cndmask_b32 v101, v101, v103, vcc
    s_waitcnt lgkmcnt(4)
    v_mfma_f32_32x32x16_bf16 v[112:127], a[56:59], v[24:27], v[112:127]
    ds_read_b64_tr_b16 v[20:21], v6 offset:17536
    ds_read_b64_tr_b16 v[22:23], v6 offset:17792
    v_cndmask_b32 v109, v109, v111, s[52:53]
    v_cvt_pk_bf16_f32 v96, v100, v101
    v_cvt_pk_bf16_f32 v104, v108, v109
    v_lshlrev_b32 v100, 16, v96
    v_lshlrev_b32 v108, 16, v104
    v_and_b32 v101, 0xffff0000, v96
    v_and_b32 v109, 0xffff0000, v104
    v_add_f32 v100, s48, v100
    v_add_f32 v108, s48, v108
    v_add_f32 v101, s49, v101
    s_waitcnt lgkmcnt(4)
    v_mfma_f32_32x32x16_bf16 v[112:127], a[60:63], v[28:31], v[112:127]
    ds_read_b64_tr_b16 v[24:25], v6 offset:18560
    ds_read_b64_tr_b16 v[26:27], v6 offset:18816
    v_add_f32 v109, s49, v109
    v_cvt_pk_bf16_f32 v14, v100, v101
    v_cvt_pk_bf16_f32 v15, v108, v109
    buffer_store_dwordx4 v[12:15], v7, s[20:23], s29 offen offset:2048 sc1
    v_cvt_pk_bf16_f32 v96, v80, v81
    v_cvt_pk_bf16_f32 v104, v82, v83
    v_lshlrev_b32 v98, 16, v96
    v_lshlrev_b32 v106, 16, v104
    v_and_b32 v99, 0xffff0000, v96
    v_and_b32 v107, 0xffff0000, v104
    s_waitcnt lgkmcnt(4)
    v_mfma_f32_32x32x16_bf16 v[112:127], a[64:67], v[16:19], v[112:127]
    ds_read_b64_tr_b16 v[28:29], v6 offset:19584
    ds_read_b64_tr_b16 v[30:31], v6 offset:19840
    v_mul_f32 v100, s46, v98
    v_mul_f32 v108, s46, v106
    v_mul_f32 v101, s47, v99
    v_mul_f32 v109, s47, v107
    v_add_f32 v102, s44, v98
    v_add_f32 v110, s44, v106
    v_add_f32 v103, s45, v99
    v_add_f32 v111, s45, v107
    v_exp_f32 v100, v100
    v_exp_f32 v108, v108
    s_waitcnt lgkmcnt(4)
    v_mfma_f32_32x32x16_bf16 v[112:127], a[68:71], v[20:23], v[112:127]
    ds_read_b64_tr_b16 v[16:17], v6 offset:20608
    ds_read_b64_tr_b16 v[18:19], v6 offset:20864
    v_exp_f32 v101, v101
    v_exp_f32 v109, v109
    v_cmp_lt_f32 vcc, 0, v98
    v_cmp_lt_f32 s[52:53], 0, v106
    s_nop 0
    v_cndmask_b32 v100, v100, v102, vcc
    v_cndmask_b32 v108, v108, v110, s[52:53]
    v_cmp_lt_f32 vcc, 0, v99
    v_cmp_lt_f32 s[52:53], 0, v107
    s_nop 0
    v_cndmask_b32 v101, v101, v103, vcc
    v_cndmask_b32 v109, v109, v111, s[52:53]
    s_waitcnt lgkmcnt(4)
    v_mfma_f32_32x32x16_bf16 v[112:127], a[72:75], v[24:27], v[112:127]
    ds_read_b64_tr_b16 v[20:21], v6 offset:21632
    ds_read_b64_tr_b16 v[22:23], v6 offset:21888
    v_cvt_pk_bf16_f32 v96, v100, v101
    v_cvt_pk_bf16_f32 v104, v108, v109
    v_lshlrev_b32 v100, 16, v96
    v_lshlrev_b32 v108, 16, v104
    v_and_b32 v101, 0xffff0000, v96
    v_and_b32 v109, 0xffff0000, v104
    v_add_f32 v100, s48, v100
    v_add_f32 v108, s48, v108
    v_add_f32 v101, s49, v101
    v_add_f32 v109, s49, v109
    s_waitcnt lgkmcnt(4)
    v_mfma_f32_32x32x16_bf16 v[112:127], a[76:79], v[28:31], v[112:127]
    ds_read_b64_tr_b16 v[24:25], v6 offset:22656
    ds_read_b64_tr_b16 v[26:27], v6 offset:22912
    v_cvt_pk_bf16_f32 v8, v100, v101
    v_cvt_pk_bf16_f32 v9, v108, v109
    v_cvt_pk_bf16_f32 v96, v84, v85
    v_cvt_pk_bf16_f32 v104, v86, v87
    v_lshlrev_b32 v98, 16, v96
    v_lshlrev_b32 v106, 16, v104
    v_and_b32 v99, 0xffff0000, v96
    v_and_b32 v107, 0xffff0000, v104
    v_mul_f32 v100, s46, v98
    v_mul_f32 v108, s46, v106
    s_waitcnt lgkmcnt(4)
    v_mfma_f32_32x32x16_bf16 v[112:127], a[80:83], v[16:19], v[112:127]
    ds_read_b64_tr_b16 v[28:29], v6 offset:23680
    ds_read_b64_tr_b16 v[30:31], v6 offset:23936
    v_mul_f32 v101, s47, v99
    v_mul_f32 v109, s47, v107
    v_add_f32 v102, s44, v98
    v_add_f32 v110, s44, v106
    v_add_f32 v103, s45, v99
    v_add_f32 v111, s45, v107
    v_exp_f32 v100, v100
    v_exp_f32 v108, v108
    v_exp_f32 v101, v101
    v_exp_f32 v109, v109
    s_waitcnt lgkmcnt(4)
    v_mfma_f32_32x32x16_bf16 v[112:127], a[84:87], v[20:23], v[112:127]
    ds_read_b64_tr_b16 v[16:17], v6 offset:24704
    ds_read_b64_tr_b16 v[18:19], v6 offset:24960
    v_cmp_lt_f32 vcc, 0, v98
    v_cmp_lt_f32 s[52:53], 0, v106
    s_nop 0
    v_cndmask_b32 v100, v100, v102, vcc
    v_cndmask_b32 v108, v108, v110, s[52:53]
    v_cmp_lt_f32 vcc, 0, v99
    v_cmp_lt_f32 s[52:53], 0, v107
    s_nop 0
    v_cndmask_b32 v101, v101, v103, vcc
    v_cndmask_b32 v109, v109, v111, s[52:53]
    v_cvt_pk_bf16_f32 v96, v100, v101
    v_cvt_pk_bf16_f32 v104, v108, v109
    s_waitcnt lgkmcnt(4)
    v_mfma_f32_32x32x16_bf16 v[112:127], a[88:91], v[24:27], v[112:127]
    ds_read_b64_tr_b16 v[20:21], v6 offset:25728
    ds_read_b64_tr_b16 v[22:23], v6 offset:25984
    v_lshlrev_b32 v100, 16, v96
    v_lshlrev_b32 v108, 16, v104
    v_and_b32 v101, 0xffff0000, v96
    v_and_b32 v109, 0xffff0000, v104
    v_add_f32 v100, s48, v100
    v_add_f32 v108, s48, v108
    v_add_f32 v101, s49, v101
    v_add_f32 v109, s49, v109
    v_cvt_pk_bf16_f32 v10, v100, v101
    v_cvt_pk_bf16_f32 v11, v108, v109
    s_waitcnt lgkmcnt(4)
    v_mfma_f32_32x32x16_bf16 v[112:127], a[92:95], v[28:31], v[112:127]
    ds_read_b64_tr_b16 v[24:25], v6 offset:26752
    ds_read_b64_tr_b16 v[26:27], v6 offset:27008
    buffer_store_dwordx4 v[8:11], v7, s[20:23], s30 offen offset:3072 sc1
    v_cvt_pk_bf16_f32 v96, v88, v89
    v_cvt_pk_bf16_f32 v104, v90, v91
    v_lshlrev_b32 v98, 16, v96
    v_lshlrev_b32 v106, 16, v104
    v_and_b32 v99, 0xffff0000, v96
    v_and_b32 v107, 0xffff0000, v104
    v_mul_f32 v100, s46, v98
    v_mul_f32 v108, s46, v106
    v_mul_f32 v101, s47, v99
    s_waitcnt lgkmcnt(4)
    v_mfma_f32_32x32x16_bf16 v[112:127], a[96:99], v[16:19], v[112:127]
    ds_read_b64_tr_b16 v[28:29], v6 offset:27776
    ds_read_b64_tr_b16 v[30:31], v6 offset:28032
    v_mul_f32 v109, s47, v107
    v_add_f32 v102, s44, v98
    v_add_f32 v110, s44, v106
    v_add_f32 v103, s45, v99
    v_add_f32 v111, s45, v107
    v_exp_f32 v100, v100
    v_exp_f32 v108, v108
    v_exp_f32 v101, v101
    v_exp_f32 v109, v109
    v_cmp_lt_f32 vcc, 0, v98
    s_waitcnt lgkmcnt(4)
    v_mfma_f32_32x32x16_bf16 v[112:127], a[100:103], v[20:23], v[112:127]
    ds_read_b64_tr_b16 v[16:17], v6 offset:28800
    ds_read_b64_tr_b16 v[18:19], v6 offset:29056
    v_cmp_lt_f32 s[52:53], 0, v106
    v_cndmask_b32 v100, v100, v102, vcc
    s_nop 0
    v_cndmask_b32 v108, v108, v110, s[52:53]
    v_cmp_lt_f32 vcc, 0, v99
    v_cmp_lt_f32 s[52:53], 0, v107
    s_nop 0
    v_cndmask_b32 v101, v101, v103, vcc
    v_cndmask_b32 v109, v109, v111, s[52:53]
    v_cvt_pk_bf16_f32 v96, v100, v101
    v_cvt_pk_bf16_f32 v104, v108, v109
    v_lshlrev_b32 v100, 16, v96
    s_waitcnt lgkmcnt(4)
    v_mfma_f32_32x32x16_bf16 v[112:127], a[104:107], v[24:27], v[112:127]
    ds_read_b64_tr_b16 v[20:21], v6 offset:29824
    ds_read_b64_tr_b16 v[22:23], v6 offset:30080
    v_lshlrev_b32 v108, 16, v104
    v_and_b32 v101, 0xffff0000, v96
    v_and_b32 v109, 0xffff0000, v104
    v_add_f32 v100, s48, v100
    v_add_f32 v108, s48, v108
    v_add_f32 v101, s49, v101
    v_add_f32 v109, s49, v109
    v_cvt_pk_bf16_f32 v12, v100, v101
    v_cvt_pk_bf16_f32 v13, v108, v109
    v_cvt_pk_bf16_f32 v96, v92, v93
    s_waitcnt lgkmcnt(4)
    v_mfma_f32_32x32x16_bf16 v[112:127], a[108:111], v[28:31], v[112:127]
    ds_read_b64_tr_b16 v[24:25], v6 offset:30848
    ds_read_b64_tr_b16 v[26:27], v6 offset:31104
    v_cvt_pk_bf16_f32 v104, v94, v95
    v_lshlrev_b32 v98, 16, v96
    v_lshlrev_b32 v106, 16, v104
    v_and_b32 v99, 0xffff0000, v96
    v_and_b32 v107, 0xffff0000, v104
    v_mul_f32 v100, s46, v98
    v_mul_f32 v108, s46, v106
    v_mul_f32 v101, s47, v99
    v_mul_f32 v109, s47, v107
    v_add_f32 v102, s44, v98
    s_waitcnt lgkmcnt(4)
    v_mfma_f32_32x32x16_bf16 v[112:127], a[112:115], v[16:19], v[112:127]
    ds_read_b64_tr_b16 v[28:29], v6 offset:31872
    ds_read_b64_tr_b16 v[30:31], v6 offset:32128
    v_add_f32 v110, s44, v106
    v_add_f32 v103, s45, v99
    v_add_f32 v111, s45, v107
    v_exp_f32 v100, v100
    v_exp_f32 v108, v108
    v_exp_f32 v101, v101
    v_exp_f32 v109, v109
    v_cmp_lt_f32 vcc, 0, v98
    v_cmp_lt_f32 s[52:53], 0, v106
    s_nop 0
    v_cndmask_b32 v100, v100, v102, vcc
    s_waitcnt lgkmcnt(4)
    v_mfma_f32_32x32x16_bf16 v[112:127], a[116:119], v[20:23], v[112:127]
    v_cndmask_b32 v108, v108, v110, s[52:53]
    v_cmp_lt_f32 vcc, 0, v99
    v_cmp_lt_f32 s[52:53], 0, v107
    s_nop 0
    v_cndmask_b32 v101, v101, v103, vcc
    v_cndmask_b32 v109, v109, v111, s[52:53]
    v_cvt_pk_bf16_f32 v96, v100, v101
    v_cvt_pk_bf16_f32 v104, v108, v109
    v_lshlrev_b32 v100, 16, v96
    v_lshlrev_b32 v108, 16, v104
    v_and_b32 v101, 0xffff0000, v96
    s_waitcnt lgkmcnt(2)
    v_mfma_f32_32x32x16_bf16 v[112:127], a[120:123], v[24:27], v[112:127]
    v_and_b32 v109, 0xffff0000, v104
    v_add_f32 v100, s48, v100
    v_add_f32 v108, s48, v108
    v_add_f32 v101, s49, v101
    v_add_f32 v109, s49, v109
    v_cvt_pk_bf16_f32 v14, v100, v101
    v_cvt_pk_bf16_f32 v15, v108, v109
    buffer_store_dwordx4 v[12:15], v7, s[20:23], s29 offen offset:3072 sc1
    s_waitcnt lgkmcnt(0)
    v_mfma_f32_32x32x16_bf16 v[112:127], a[124:127], v[28:31], v[112:127]
L_k1_kvepi:
    s_nop 7
    s_nop 4
    v_cvt_pk_bf16_f32 v96, v112, v113
    v_cvt_pk_bf16_f32 v104, v114, v115
    v_lshlrev_b32 v98, 16, v96
    v_lshlrev_b32 v106, 16, v104
    v_and_b32 v99, 0xffff0000, v96
    v_and_b32 v107, 0xffff0000, v104
    v_mul_f32 v100, s46, v98
    v_mul_f32 v108, s46, v106
    v_mul_f32 v101, s47, v99
    v_mul_f32 v109, s47, v107
    v_add_f32 v102, s44, v98
    v_add_f32 v110, s44, v106
    v_add_f32 v103, s45, v99
    v_add_f32 v111, s45, v107
    v_exp_f32 v100, v100
    v_exp_f32 v108, v108
    v_exp_f32 v101, v101
    v_exp_f32 v109, v109
    v_cmp_lt_f32 vcc, 0, v98
    v_cmp_lt_f32 s[52:53], 0, v106
    s_nop 0
    v_cndmask_b32 v100, v100, v102, vcc
    v_cndmask_b32 v108, v108, v110, s[52:53]
    v_cmp_lt_f32 vcc, 0, v99
    v_cmp_lt_f32 s[52:53], 0, v107
    s_nop 0
    v_cndmask_b32 v101, v101, v103, vcc
    v_cndmask_b32 v109, v109, v111, s[52:53]
    v_cvt_pk_bf16_f32 v96, v100, v101
    v_cvt_pk_bf16_f32 v104, v108, v109
    v_lshlrev_b32 v100, 16, v96
    v_lshlrev_b32 v108, 16, v104
    v_and_b32 v101, 0xffff0000, v96
    v_and_b32 v109, 0xffff0000, v104
    v_add_f32 v100, s48, v100
    v_add_f32 v108, s48, v108
    v_add_f32 v101, s49, v101
    v_add_f32 v109, s49, v109
    v_cvt_pk_bf16_f32 v32, v100, v101
    v_cvt_pk_bf16_f32 v33, v108, v109
    v_cvt_pk_bf16_f32 v97, v112, v113
    v_cvt_pk_bf16_f32 v105, v114, v115
    v_cndmask_b32 v48, v97, v32, s[50:51]
    v_cndmask_b32 v49, v105, v33, s[50:51]
    v_cvt_pk_bf16_f32 v96, v116, v117
    v_cvt_pk_bf16_f32 v104, v118, v119
    v_lshlrev_b32 v98, 16, v96
    v_lshlrev_b32 v106, 16, v104
    v_and_b32 v99, 0xffff0000, v96
    v_and_b32 v107, 0xffff0000, v104
    v_mul_f32 v100, s46, v98
    v_mul_f32 v108, s46, v106
    v_mul_f32 v101, s47, v99
    v_mul_f32 v109, s47, v107
    v_add_f32 v102, s44, v98
    v_add_f32 v110, s44, v106
    v_add_f32 v103, s45, v99
    v_add_f32 v111, s45, v107
    v_exp_f32 v100, v100
    v_exp_f32 v108, v108
    v_exp_f32 v101, v101
    v_exp_f32 v109, v109
    v_cmp_lt_f32 vcc, 0, v98
    v_cmp_lt_f32 s[52:53], 0, v106
    s_nop 0
    v_cndmask_b32 v100, v100, v102, vcc
    v_cndmask_b32 v108, v108, v110, s[52:53]
    v_cmp_lt_f32 vcc, 0, v99
    v_cmp_lt_f32 s[52:53], 0, v107
    s_nop 0
    v_cndmask_b32 v101, v101, v103, vcc
    v_cndmask_b32 v109, v109, v111, s[52:53]
    v_cvt_pk_bf16_f32 v96, v100, v101
    v_cvt_pk_bf16_f32 v104, v108, v109
    v_lshlrev_b32 v100, 16, v96
    v_lshlrev_b32 v108, 16, v104
    v_and_b32 v101, 0xffff0000, v96
    v_and_b32 v109, 0xffff0000, v104
    v_add_f32 v100, s48, v100
    v_add_f32 v108, s48, v108
    v_add_f32 v101, s49, v101
    v_add_f32 v109, s49, v109
    v_cvt_pk_bf16_f32 v34, v100, v101
    v_cvt_pk_bf16_f32 v35, v108, v109
    v_cvt_pk_bf16_f32 v97, v116, v117
    v_cvt_pk_bf16_f32 v105, v118, v119
    v_cndmask_b32 v50, v97, v34, s[50:51]
    v_cndmask_b32 v51, v105, v35, s[50:51]
    v_cvt_pk_bf16_f32 v96, v120, v121
    v_cvt_pk_bf16_f32 v104, v122, v123
    v_lshlrev_b32 v98, 16, v96
    v_lshlrev_b32 v106, 16, v104
    v_and_b32 v99, 0xffff0000, v96
    v_and_b32 v107, 0xffff0000, v104
    v_mul_f32 v100, s46, v98
    v_mul_f32 v108, s46, v106
    v_mul_f32 v101, s47, v99
    v_mul_f32 v109, s47, v107
    v_add_f32 v102, s44, v98
    v_add_f32 v110, s44, v106
    v_add_f32 v103, s45, v99
    v_add_f32 v111, s45, v107
    v_exp_f32 v100, v100
    v_exp_f32 v108, v108
    v_exp_f32 v101, v101
    v_exp_f32 v109, v109
    v_cmp_lt_f32 vcc, 0, v98
    v_cmp_lt_f32 s[52:53], 0, v106
    s_nop 0
    v_cndmask_b32 v100, v100, v102, vcc
    v_cndmask_b32 v108, v108, v110, s[52:53]
    v_cmp_lt_f32 vcc, 0, v99
    v_cmp_lt_f32 s[52:53], 0, v107
    s_nop 0
    v_cndmask_b32 v101, v101, v103, vcc
    v_cndmask_b32 v109, v109, v111, s[52:53]
    v_cvt_pk_bf16_f32 v96, v100, v101
    v_cvt_pk_bf16_f32 v104, v108, v109
    v_lshlrev_b32 v100, 16, v96
    v_lshlrev_b32 v108, 16, v104
    v_and_b32 v101, 0xffff0000, v96
    v_and_b32 v109, 0xffff0000, v104
    v_add_f32 v100, s48, v100
    v_add_f32 v108, s48, v108
    v_add_f32 v101, s49, v101
    v_add_f32 v109, s49, v109
    v_cvt_pk_bf16_f32 v36, v100, v101
    v_cvt_pk_bf16_f32 v37, v108, v109
    v_cvt_pk_bf16_f32 v97, v120, v121
    v_cvt_pk_bf16_f32 v105, v122, v123
    v_cndmask_b32 v52, v97, v36, s[50:51]
    v_cndmask_b32 v53, v105, v37, s[50:51]
    v_cvt_pk_bf16_f32 v96, v124, v125
    v_cvt_pk_bf16_f32 v104, v126, v127
    v_lshlrev_b32 v98, 16, v96
    v_lshlrev_b32 v106, 16, v104
    v_and_b32 v99, 0xffff0000, v96
    v_and_b32 v107, 0xffff0000, v104
    v_mul_f32 v100, s46, v98
    v_mul_f32 v108, s46, v106
    v_mul_f32 v101, s47, v99
    v_mul_f32 v109, s47, v107
    v_add_f32 v102, s44, v98
    v_add_f32 v110, s44, v106
    v_add_f32 v103, s45, v99
    v_add_f32 v111, s45, v107
    v_exp_f32 v100, v100
    v_exp_f32 v108, v108
    v_exp_f32 v101, v101
    v_exp_f32 v109, v109
    v_cmp_lt_f32 vcc, 0, v98
    v_cmp_lt_f32 s[52:53], 0, v106
    s_nop 0
    v_cndmask_b32 v100, v100, v102, vcc
    v_cndmask_b32 v108, v108, v110, s[52:53]
    v_cmp_lt_f32 vcc, 0, v99
    v_cmp_lt_f32 s[52:53], 0, v107
    s_nop 0
    v_cndmask_b32 v101, v101, v103, vcc
    v_cndmask_b32 v109, v109, v111, s[52:53]
    v_cvt_pk_bf16_f32 v96, v100, v101
    v_cvt_pk_bf16_f32 v104, v108, v109
    v_lshlrev_b32 v100, 16, v96
    v_lshlrev_b32 v108, 16, v104
    v_and_b32 v101, 0xffff0000, v96
    v_and_b32 v109, 0xffff0000, v104
    v_add_f32 v100, s48, v100
    v_add_f32 v108, s48, v108
    v_add_f32 v101, s49, v101
    v_add_f32 v109, s49, v109
    v_cvt_pk_bf16_f32 v38, v100, v101
    v_cvt_pk_bf16_f32 v39, v108, v109
    v_cvt_pk_bf16_f32 v97, v124, v125
    v_cvt_pk_bf16_f32 v105, v126, v127
    v_cndmask_b32 v54, v97, v38, s[50:51]
    v_cndmask_b32 v55, v105, v39, s[50:51]
    v_mov_b32 v96, 0x3f803f80
    v_mov_b32 v97, 0x3f803f80
    v_mov_b32 v98, 0x3f803f80
    v_mov_b32 v99, 0x3f803f80
    v_mfma_f32_32x32x16_bf16 v[64:79], v[48:51], v[48:51], 0
    s_nop 0
    v_mfma_f32_32x32x16_bf16 v[80:95], v[48:51], v[96:99], 0
    v_mfma_f32_32x32x16_bf16 v[64:79], v[52:55], v[52:55], v[64:79]
    v_mfma_f32_32x32x16_bf16 v[80:95], v[52:55], v[96:99], v[80:95]
    s_nop 11
    v_cndmask_b32 v100, v72, v88, s[50:51]
    v_cndmask_b32 v101, v73, v89, s[50:51]
    v_cndmask_b32 v102, v74, v90, s[50:51]
    v_cndmask_b32 v103, v75, v91, s[50:51]
    v_cndmask_b32 v104, v76, v92, s[50:51]
    v_cndmask_b32 v105, v77, v93, s[50:51]
    v_cndmask_b32 v106, v78, v94, s[50:51]
    v_cndmask_b32 v107, v79, v95, s[50:51]
    s_lshl_b32 s29, s16, 11
    v_add_u32 v96, s29, v7
    ds_write_b128 v96, v[100:103] offset:33024
    ds_write_b128 v96, v[104:107] offset:34048
    s_waitcnt lgkmcnt(0)
    s_barrier
    s_lshl_b32 s29, s16, 8
    v_lshlrev_b32 v96, 2, v2
    v_add_u32 v96, s29, v96
    ds_read_b32 v100, v96 offset:33024
    ds_read_b32 v101, v96 offset:35072
    ds_read_b32 v102, v96 offset:37120
    ds_read_b32 v103, v96 offset:39168
    ds_read_b32 v104, v96 offset:41216
    ds_read_b32 v105, v96 offset:43264
    ds_read_b32 v106, v96 offset:45312
    ds_read_b32 v107, v96 offset:47360
    s_lshl_b32 s30, s14, 11
    s_add_u32 s30, s30, s29
    s_add_u32 s30, s30, 11534336
    v_lshlrev_b32 v97, 2, v2
    s_waitcnt lgkmcnt(0)
    v_add_f32 v100, v100, v101
    v_add_f32 v102, v102, v103
    v_add_f32 v104, v104, v105
    v_add_f32 v106, v106, v107
    v_add_f32 v100, v100, v102
    v_add_f32 v104, v104, v106
    v_add_f32 v100, v100, v104
    buffer_atomic_add_f32 v100, v97, s[20:23], s30 offen
L_k1_end:
    s_endpgm
.globl k2_kernel
.p2align 8
.type k2_kernel,@function
k2_kernel:
    s_cmp_ge_u32 s2, 256
    s_cbranch_scc1 L_k2_end
    s_load_dwordx2 s[4:5], s[0:1], 0
    s_load_dwordx2 s[6:7], s[0:1], 16
    s_load_dwordx2 s[8:9], s[0:1], 48
    s_load_dwordx2 s[10:11], s[0:1], 56
    s_load_dwordx2 s[12:13], s[0:1], 72
    v_lshrrev_b32 v1, 6, v0
    v_and_b32 v2, 63, v0
    s_and_b32 s14, s2, 7
    s_lshr_b32 s15, s2, 3
    s_lshl_b32 s16, s14, 2
    s_and_b32 s17, s15, 3
    s_add_u32 s16, s16, s17
    s_lshr_b32 s17, s15, 2
    v_readfirstlane_b32 s18, v1
    s_mov_b32 s44, 1.0
    s_mov_b32 s45, 1.0
    s_mov_b32 s46, 0xbfb8aa3b
    s_mov_b32 s47, 0xbfb8aa3b
    s_waitcnt lgkmcnt(0)
    s_mov_b32 s20, s12
    s_mov_b32 s21, s13
    s_mov_b32 s22, 268435456
    s_mov_b32 s23, 0x00020000
    s_mov_b32 s24, s8
    s_mov_b32 s25, s9
    s_mov_b32 s26, 1835008
    s_mov_b32 s27, 0x00020000
    s_mov_b32 s28, s6
    s_mov_b32 s29, s7
    s_mov_b32 s30, 524288
    s_mov_b32 s31, 0x00020000
    s_mov_b32 s32, s4
    s_mov_b32 s33, s5
    s_mov_b32 s34, 2097152
    s_mov_b32 s35, 0x00020000
    s_mov_b32 s36, s10
    s_mov_b32 s37, s11
    s_mov_b32 s38, 2097152
    s_mov_b32 s39, 0x00020000
    v_lshrrev_b32 v3, 3, v2
    v_lshlrev_b32 v3, 10, v3
    v_bfe_u32 v4, v2, 1, 2
    v_bfe_u32 v5, v2, 4, 1
    v_lshlrev_b32 v5, 1, v5
    v_xor_b32 v4, v4, v5
    v_lshlrev_b32 v4, 5, v4
    v_and_b32 v5, 1, v2
    v_lshlrev_b32 v5, 4, v5
    v_add3_u32 v3, v3, v4, v5
    s_lshl_b32 s19, s17, 7
    v_add_u32 v3, s19, v3
    v_lshrrev_b32 v8, 5, v2
    v_lshlrev_b32 v8, 2, v8
    v_bfe_u32 v9, v2, 2, 2
    v_add_u32 v8, v8, v9
    v_lshlrev_b32 v8, 7, v8
    v_and_b32 v9, 3, v2
    v_lshlrev_b32 v9, 3, v9
    v_add_u32 v8, v8, v9
    s_mul_i32 s19, s18, 20480
    v_add_u32 v8, s19, v8
    v_bfe_u32 v9, v2, 4, 1
    v_bfe_u32 v10, v2, 3, 1
    v_lshlrev_b32 v10, 1, v10
    v_add_u32 v11, 0, v9
    v_xor_b32 v11, v11, v10
    v_lshlrev_b32 v11, 5, v11
    v_add_u32 v4, v8, v11
    v_add_u32 v11, 2, v9
    v_xor_b32 v11, v11, v10
    v_lshlrev_b32 v11, 5, v11
    v_add_u32 v5, v8, v11
    v_lshlrev_b32 v6, 4, v2
    s_lshr_b32 s40, s18, 1
    s_lshl_b32 s41, s16, 1
    s_add_u32 s40, s40, s41
    s_lshl_b32 s40, s40, 5
    v_and_b32 v7, 31, v2
    v_add_u32 v7, s40, v7
    v_lshlrev_b32 v7, 10, v7
    v_lshrrev_b32 v8, 5, v2
    v_lshlrev_b32 v8, 3, v8
    v_add_u32 v7, v7, v8
    s_lshl_b32 s40, s17, 7
    s_and_b32 s41, s18, 1
    s_lshl_b32 s41, s41, 6
    s_add_u32 s40, s40, s41
    v_add_u32 v7, s40, v7
    s_lshl_b32 s48, s16, 1
    s_mul_i32 s48, s48, 112
    s_mul_i32 s49, s18, 28
    s_add_u32 s48, s48, s49
    s_lshl_b32 s48, s48, 10
    s_add_u32 s48, s48, 2097152
    s_mul_i32 s50, s18, 458752
    s_mul_i32 s51, s18, 20480
    s_lshl_b32 s52, s16, 1
    s_lshl_b32 s52, s52, 5
    s_lshl_b32 s53, s18, 3
    s_add_u32 s52, s52, s53
    s_lshl_b32 s52, s52, 10
    s_add_u32 s52, s52, 9437184
    s_lshl_b32 s54, s18, 14
    s_add_u32 s54, s54, 11534336
    s_lshl_b32 s55, s18, 17
    s_add_u32 s41, s48, 0
    buffer_load_dwordx4 a[0:3], v6, s[20:23], s41 offen
    s_add_u32 s41, s41, 114688
    buffer_load_dwordx4 a[4:7], v6, s[20:23], s41 offen
    s_add_u32 m0, s51, 0
    s_add_u32 s41, s50, 0
    buffer_load_dwordx4 v3, s[24:27], s41 offen lds
    s_add_u32 m0, s51, 1024
    s_add_u32 s41, s41, 8192
    buffer_load_dwordx4 v3, s[24:27], s41 offen lds
    s_add_u32 s41, s48, 1024
    buffer_load_dwordx4 a[8:11], v6, s[20:23], s41 offen
    s_add_u32 s41, s41, 114688
    buffer_load_dwordx4 a[12:15], v6, s[20:23], s41 offen
    s_add_u32 m0, s51, 2048
    s_add_u32 s41, s50, 16384
    buffer_load_dwordx4 v3, s[24:27], s41 offen lds
    s_add_u32 m0, s51, 3072
    s_add_u32 s41, s41, 8192
    buffer_load_dwordx4 v3, s[24:27], s41 offen lds
    s_add_u32 s41, s48, 2048
    buffer_load_dwordx4 a[16:19], v6, s[20:23], s41 offen
    s_add_u32 s41, s41, 114688
    buffer_load_dwordx4 a[20:23], v6, s[20:23], s41 offen
    s_add_u32 m0, s51, 4096
    s_add_u32 s41, s50, 32768
    buffer_load_dwordx4 v3, s[24:27], s41 offen lds
    s_add_u32 m0, s51, 5120
    s_add_u32 s41, s41, 8192
    buffer_load_dwordx4 v3, s[24:27], s41 offen lds
    s_add_u32 s41, s48, 3072
    buffer_load_dwordx4 a[24:27], v6, s[20:23], s41 offen
    s_add_u32 s41, s41, 114688
    buffer_load_dwordx4 a[28:31], v6, s[20:23], s41 offen
    s_add_u32 m0, s51, 6144
    s_add_u32 s41, s50, 49152
    buffer_load_dwordx4 v3, s[24:27], s41 offen lds
    s_add_u32 m0, s51, 7168
    s_add_u32 s41, s41, 8192
    buffer_load_dwordx4 v3, s[24:27], s41 offen lds
    s_add_u32 s41, s48, 4096
    buffer_load_dwordx4 a[32:35], v6, s[20:23], s41 offen
    s_add_u32 s41, s41, 114688
    buffer_load_dwordx4 a[36:39], v6, s[20:23], s41 offen
    s_add_u32 m0, s51, 8192
    s_add_u32 s41, s50, 65536
    buffer_load_dwordx4 v3, s[24:27], s41 offen lds
    s_add_u32 m0, s51, 9216
    s_add_u32 s41, s41, 8192
    buffer_load_dwordx4 v3, s[24:27], s41 offen lds
    s_add_u32 s41, s48, 5120
    buffer_load_dwordx4 a[40:43], v6, s[20:23], s41 offen
    s_add_u32 s41, s41, 114688
    buffer_load_dwordx4 a[44:47], v6, s[20:23], s41 offen
    s_add_u32 m0, s51, 10240
    s_add_u32 s41, s50, 81920
    buffer_load_dwordx4 v3, s[24:27], s41 offen lds
    s_add_u32 m0, s51, 11264
    s_add_u32 s41, s41, 8192
    buffer_load_dwordx4 v3, s[24:27], s41 offen lds
    s_add_u32 s41, s48, 6144
    buffer_load_dwordx4 a[48:51], v6, s[20:23], s41 offen
    s_add_u32 s41, s41, 114688
    buffer_load_dwordx4 a[52:55], v6, s[20:23], s41 offen
    s_add_u32 m0, s51, 12288
    s_add_u32 s41, s50, 98304
    buffer_load_dwordx4 v3, s[24:27], s41 offen lds
    s_add_u32 m0, s51, 13312
    s_add_u32 s41, s41, 8192
    buffer_load_dwordx4 v3, s[24:27], s41 offen lds
    s_add_u32 s41, s48, 7168
    buffer_load_dwordx4 a[56:59], v6, s[20:23], s41 offen
    s_add_u32 s41, s41, 114688
    buffer_load_dwordx4 a[60:63], v6, s[20:23], s41 offen
    s_add_u32 m0, s51, 14336
    s_add_u32 s41, s50, 114688
    buffer_load_dwordx4 v3, s[24:27], s41 offen lds
    s_add_u32 m0, s51, 15360
    s_add_u32 s41, s41, 8192
    buffer_load_dwordx4 v3, s[24:27], s41 offen lds
    buffer_load_dwordx4 v[128:131], v6, s[20:23], s54 offen offset:0
    buffer_load_dwordx4 v[132:135], v6, s[20:23], s54 offen offset:1024
    s_add_u32 s54, s54, 2048
    buffer_load_dwordx4 v[136:139], v6, s[20:23], s54 offen offset:0
    buffer_load_dwordx4 v[140:143], v6, s[20:23], s54 offen offset:1024
    s_add_u32 s54, s54, 2048
    buffer_load_dwordx4 v[144:147], v6, s[20:23], s54 offen offset:0
    buffer_load_dwordx4 v[148:151], v6, s[20:23], s54 offen offset:1024
    s_add_u32 s54, s54, 2048
    buffer_load_dwordx4 v[152:155], v6, s[20:23], s54 offen offset:0
    buffer_load_dwordx4 v[156:159], v6, s[20:23], s54 offen offset:1024
    s_add_u32 s54, s54, 2048
    buffer_load_dwordx4 v[160:163], v6, s[20:23], s54 offen offset:0
    buffer_load_dwordx4 v[164:167], v6, s[20:23], s54 offen offset:1024
    s_add_u32 s54, s54, 2048
    buffer_load_dwordx4 v[168:171], v6, s[20:23], s54 offen offset:0
    buffer_load_dwordx4 v[172:175], v6, s[20:23], s54 offen offset:1024
    s_add_u32 s54, s54, 2048
    buffer_load_dwordx4 v[176:179], v6, s[20:23], s54 offen offset:0
    buffer_load_dwordx4 v[180:183], v6, s[20:23], s54 offen offset:1024
    s_add_u32 s54, s54, 2048
    buffer_load_dwordx4 v[184:187], v6, s[20:23], s54 offen offset:0
    buffer_load_dwordx4 v[188:191], v6, s[20:23], s54 offen offset:1024
    s_add_u32 s54, s54, 2048
    buffer_load_dwordx2 v[8:9], v7, s[32:35], 0 offen offset:0
    buffer_load_dwordx2 v[10:11], v7, s[32:35], 0 offen offset:16
    buffer_load_dwordx2 v[12:13], v7, s[32:35], 0 offen offset:32
    buffer_load_dwordx2 v[14:15], v7, s[32:35], 0 offen offset:48
    s_waitcnt vmcnt(48)
    ds_read_b64_tr_b16 v[16:17], v4 offset:0
    ds_read_b64_tr_b16 v[18:19], v4 offset:1024
    ds_read_b64_tr_b16 v[20:21], v5 offset:0
    ds_read_b64_tr_b16 v[22:23], v5 offset:1024
    s_add_u32 s41, s48, 8192
    buffer_load_dwordx4 a[64:67], v6, s[20:23], s41 offen
    s_add_u32 s41, s41, 114688
    buffer_load_dwordx4 a[68:71], v6, s[20:23], s41 offen
    s_add_u32 m0, s51, 16384
    s_add_u32 s41, s50, 131072
    buffer_load_dwordx4 v3, s[24:27], s41 offen lds
    s_add_u32 m0, s51, 17408
    s_add_u32 s41, s41, 8192
    buffer_load_dwordx4 v3, s[24:27], s41 offen lds
    s_waitcnt vmcnt(48)
    ds_read_b64_tr_b16 v[24:25], v4 offset:2048
    ds_read_b64_tr_b16 v[26:27], v4 offset:3072
    ds_read_b64_tr_b16 v[28:29], v5 offset:2048
    ds_read_b64_tr_b16 v[30:31], v5 offset:3072
    s_waitcnt lgkmcnt(4)
    v_mfma_f32_32x32x16_bf16 v[64:79], v[16:19], a[0:3], 0
    v_mfma_f32_32x32x16_bf16 v[80:95], v[20:23], a[0:3], 0
    v_mfma_f32_32x32x16_bf16 v[96:111], v[16:19], a[4:7], 0
    v_mfma_f32_32x32x16_bf16 v[112:127], v[20:23], a[4:7], 0
    s_add_u32 s41, s48, 9216
    buffer_load_dwordx4 a[0:3], v6, s[20:23], s41 offen
    s_add_u32 s41, s41, 114688
    buffer_load_dwordx4 a[4:7], v6, s[20:23], s41 offen
    s_add_u32 m0, s51, 18432
    s_add_u32 s41, s50, 147456
    buffer_load_dwordx4 v3, s[24:27], s41 offen lds
    s_add_u32 m0, s51, 19456
    s_add_u32 s41, s41, 8192
    buffer_load_dwordx4 v3, s[24:27], s41 offen lds
    s_waitcnt vmcnt(48)
    ds_read_b64_tr_b16 v[16:17], v4 offset:4096
    ds_read_b64_tr_b16 v[18:19], v4 offset:5120
    ds_read_b64_tr_b16 v[20:21], v5 offset:4096
    ds_read_b64_tr_b16 v[22:23], v5 offset:5120
    s_waitcnt lgkmcnt(4)
    v_mfma_f32_32x32x16_bf16 v[64:79], v[24:27], a[8:11], v[64:79]
    v_mfma_f32_32x32x16_bf16 v[80:95], v[28:31], a[8:11], v[80:95]
    v_mfma_f32_32x32x16_bf16 v[96:111], v[24:27], a[12:15], v[96:111]
    v_mfma_f32_32x32x16_bf16 v[112:127], v[28:31], a[12:15], v[112:127]
    s_add_u32 s41, s48, 10240
    buffer_load_dwordx4 a[8:11], v6, s[20:23], s41 offen
    s_add_u32 s41, s41, 114688
    buffer_load_dwordx4 a[12:15], v6, s[20:23], s41 offen
    s_add_u32 m0, s51, 0
    s_add_u32 s41, s50, 163840
    buffer_load_dwordx4 v3, s[24:27], s41 offen lds
    s_add_u32 m0, s51, 1024
    s_add_u32 s41, s41, 8192
    buffer_load_dwordx4 v3, s[24:27], s41 offen lds
    s_waitcnt vmcnt(48)
    ds_read_b64_tr_b16 v[24:25], v4 offset:6144
    ds_read_b64_tr_b16 v[26:27], v4 offset:7168
    ds_read_b64_tr_b16 v[28:29], v5 offset:6144
    ds_read_b64_tr_b16 v[30:31], v5 offset:7168
    s_waitcnt lgkmcnt(4)
    v_mfma_f32_32x32x16_bf16 v[64:79], v[16:19], a[16:19], v[64:79]
    v_mfma_f32_32x32x16_bf16 v[80:95], v[20:23], a[16:19], v[80:95]
    v_mfma_f32_32x32x16_bf16 v[96:111], v[16:19], a[20:23], v[96:111]
    v_mfma_f32_32x32x16_bf16 v[112:127], v[20:23], a[20:23], v[112:127]
    s_add_u32 s41, s48, 11264
    buffer_load_dwordx4 a[16:19], v6, s[20:23], s41 offen
    s_add_u32 s41, s41, 114688
    buffer_load_dwordx4 a[20:23], v6, s[20:23], s41 offen
    s_add_u32 m0, s51, 2048
    s_add_u32 s41, s50, 180224
    buffer_load_dwordx4 v3, s[24:27], s41 offen lds
    s_add_u32 m0, s51, 3072
    s_add_u32 s41, s41, 8192
    buffer_load_dwordx4 v3, s[24:27], s41 offen lds
    s_waitcnt vmcnt(48)
    ds_read_b64_tr_b16 v[16:17], v4 offset:8192
    ds_read_b64_tr_b16 v[18:19], v4 offset:9216
    ds_read_b64_tr_b16 v[20:21], v5 offset:8192
    ds_read_b64_tr_b16 v[22:23], v5 offset:9216
    s_waitcnt lgkmcnt(4)
    v_mfma_f32_32x32x16_bf16 v[64:79], v[24:27], a[24:27], v[64:79]
    v_mfma_f32_32x32x16_bf16 v[80:95], v[28:31], a[24:27], v[80:95]
    v_mfma_f32_32x32x16_bf16 v[96:111], v[24:27], a[28:31], v[96:111]
    v_mfma_f32_32x32x16_bf16 v[112:127], v[28:31], a[28:31], v[112:127]
    s_add_u32 s41, s48, 12288
    buffer_load_dwordx4 a[24:27], v6, s[20:23], s41 offen
    s_add_u32 s41, s41, 114688
    buffer_load_dwordx4 a[28:31], v6, s[20:23], s41 offen
    s_add_u32 m0, s51, 4096
    s_add_u32 s41, s50, 196608
    buffer_load_dwordx4 v3, s[24:27], s41 offen lds
    s_add_u32 m0, s51, 5120
    s_add_u32 s41, s41, 8192
    buffer_load_dwordx4 v3, s[24:27], s41 offen lds
    s_waitcnt vmcnt(48)
    ds_read_b64_tr_b16 v[24:25], v4 offset:10240
    ds_read_b64_tr_b16 v[26:27], v4 offset:11264
    ds_read_b64_tr_b16 v[28:29], v5 offset:10240
    ds_read_b64_tr_b16 v[30:31], v5 offset:11264
    s_waitcnt lgkmcnt(4)
    v_mfma_f32_32x32x16_bf16 v[64:79], v[16:19], a[32:35], v[64:79]
    v_mfma_f32_32x32x16_bf16 v[80:95], v[20:23], a[32:35], v[80:95]
    v_mfma_f32_32x32x16_bf16 v[96:111], v[16:19], a[36:39], v[96:111]
    v_mfma_f32_32x32x16_bf16 v[112:127], v[20:23], a[36:39], v[112:127]
    s_add_u32 s41, s48, 13312
    buffer_load_dwordx4 a[32:35], v6, s[20:23], s41 offen
    s_add_u32 s41, s41, 114688
    buffer_load_dwordx4 a[36:39], v6, s[20:23], s41 offen
    s_add_u32 m0, s51, 6144
    s_add_u32 s41, s50, 212992
    buffer_load_dwordx4 v3, s[24:27], s41 offen lds
    s_add_u32 m0, s51, 7168
    s_add_u32 s41, s41, 8192
    buffer_load_dwordx4 v3, s[24:27], s41 offen lds
    s_waitcnt vmcnt(48)
    ds_read_b64_tr_b16 v[16:17], v4 offset:12288
    ds_read_b64_tr_b16 v[18:19], v4 offset:13312
    ds_read_b64_tr_b16 v[20:21], v5 offset:12288
    ds_read_b64_tr_b16 v[22:23], v5 offset:13312
    s_waitcnt lgkmcnt(4)
    v_mfma_f32_32x32x16_bf16 v[64:79], v[24:27], a[40:43], v[64:79]
    v_mfma_f32_32x32x16_bf16 v[80:95], v[28:31], a[40:43], v[80:95]
    v_mfma_f32_32x32x16_bf16 v[96:111], v[24:27], a[44:47], v[96:111]
    v_mfma_f32_32x32x16_bf16 v[112:127], v[28:31], a[44:47], v[112:127]
    s_add_u32 s41, s48, 14336
    buffer_load_dwordx4 a[40:43], v6, s[20:23], s41 offen
    s_add_u32 s41, s41, 114688
    buffer_load_dwordx4 a[44:47], v6, s[20:23], s41 offen
    s_add_u32 m0, s51, 8192
    s_add_u32 s41, s50, 229376
    buffer_load_dwordx4 v3, s[24:27], s41 offen lds
    s_add_u32 m0, s51, 9216
    s_add_u32 s41, s41, 8192
    buffer_load_dwordx4 v3, s[24:27], s41 offen lds
    s_waitcnt vmcnt(48)
    ds_read_b64_tr_b16 v[24:25], v4 offset:14336
    ds_read_b64_tr_b16 v[26:27], v4 offset:15360
    ds_read_b64_tr_b16 v[28:29], v5 offset:14336
    ds_read_b64_tr_b16 v[30:31], v5 offset:15360
    s_waitcnt lgkmcnt(4)
    v_mfma_f32_32x32x16_bf16 v[64:79], v[16:19], a[48:51], v[64:79]
    v_mfma_f32_32x32x16_bf16 v[80:95], v[20:23], a[48:51], v[80:95]
    v_mfma_f32_32x32x16_bf16 v[96:111], v[16:19], a[52:55], v[96:111]
    v_mfma_f32_32x32x16_bf16 v[112:127], v[20:23], a[52:55], v[112:127]
    s_add_u32 s41, s48, 15360
    buffer_load_dwordx4 a[48:51], v6, s[20:23], s41 offen
    s_add_u32 s41, s41, 114688
    buffer_load_dwordx4 a[52:55], v6, s[20:23], s41 offen
    s_add_u32 m0, s51, 10240
    s_add_u32 s41, s50, 245760
    buffer_load_dwordx4 v3, s[24:27], s41 offen lds
    s_add_u32 m0, s51, 11264
    s_add_u32 s41, s41, 8192
    buffer_load_dwordx4 v3, s[24:27], s41 offen lds
    s_waitcnt vmcnt(28)
    ds_read_b64_tr_b16 v[16:17], v4 offset:16384
    ds_read_b64_tr_b16 v[18:19], v4 offset:17408
    ds_read_b64_tr_b16 v[20:21], v5 offset:16384
    ds_read_b64_tr_b16 v[22:23], v5 offset:17408
    s_waitcnt lgkmcnt(4)
    v_mfma_f32_32x32x16_bf16 v[64:79], v[24:27], a[56:59], v[64:79]
    v_mfma_f32_32x32x16_bf16 v[80:95], v[28:31], a[56:59], v[80:95]
    v_mfma_f32_32x32x16_bf16 v[96:111], v[24:27], a[60:63], v[96:111]
    v_mfma_f32_32x32x16_bf16 v[112:127], v[28:31], a[60:63], v[112:127]
    s_add_u32 s41, s48, 16384
    buffer_load_dwordx4 a[56:59], v6, s[20:23], s41 offen
    s_add_u32 s41, s41, 114688
    buffer_load_dwordx4 a[60:63], v6, s[20:23], s41 offen
    s_add_u32 m0, s51, 12288
    s_add_u32 s41, s50, 262144
    buffer_load_dwordx4 v3, s[24:27], s41 offen lds
    s_add_u32 m0, s51, 13312
    s_add_u32 s41, s41, 8192
    buffer_load_dwordx4 v3, s[24:27], s41 offen lds
    s_waitcnt vmcnt(28)
    ds_read_b64_tr_b16 v[24:25], v4 offset:18432
    ds_read_b64_tr_b16 v[26:27], v4 offset:19456
    ds_read_b64_tr_b16 v[28:29], v5 offset:18432
    ds_read_b64_tr_b16 v[30:31], v5 offset:19456
    s_waitcnt lgkmcnt(4)
    v_mfma_f32_32x32x16_bf16 v[64:79], v[16:19], a[64:67], v[64:79]
    v_mfma_f32_32x32x16_bf16 v[80:95], v[20:23], a[64:67], v[80:95]
    v_mfma_f32_32x32x16_bf16 v[96:111], v[16:19], a[68:71], v[96:111]
    v_mfma_f32_32x32x16_bf16 v[112:127], v[20:23], a[68:71], v[112:127]
    s_add_u32 s41, s48, 17408
    buffer_load_dwordx4 a[64:67], v6, s[20:23], s41 offen
    s_add_u32 s41, s41, 114688
    buffer_load_dwordx4 a[68:71], v6, s[20:23], s41 offen
    s_add_u32 m0, s51, 14336
    s_add_u32 s41, s50, 278528
    buffer_load_dwordx4 v3, s[24:27], s41 offen lds
    s_add_u32 m0, s51, 15360
    s_add_u32 s41, s41, 8192
    buffer_load_dwordx4 v3, s[24:27], s41 offen lds
    s_waitcnt vmcnt(28)
    ds_read_b64_tr_b16 v[16:17], v4 offset:0
    ds_read_b64_tr_b16 v[18:19], v4 offset:1024
    ds_read_b64_tr_b16 v[20:21], v5 offset:0
    ds_read_b64_tr_b16 v[22:23], v5 offset:1024
    s_waitcnt lgkmcnt(4)
    v_mfma_f32_32x32x16_bf16 v[64:79], v[24:27], a[0:3], v[64:79]
    v_mfma_f32_32x32x16_bf16 v[80:95], v[28:31], a[0:3], v[80:95]
    v_mfma_f32_32x32x16_bf16 v[96:111], v[24:27], a[4:7], v[96:111]
    v_mfma_f32_32x32x16_bf16 v[112:127], v[28:31], a[4:7], v[112:127]
    s_add_u32 s41, s48, 18432
    buffer_load_dwordx4 a[0:3], v6, s[20:23], s41 offen
    s_add_u32 s41, s41, 114688
    buffer_load_dwordx4 a[4:7], v6, s[20:23], s41 offen
    s_add_u32 m0, s51, 16384
    s_add_u32 s41, s50, 294912
    buffer_load_dwordx4 v3, s[24:27], s41 offen lds
    s_add_u32 m0, s51, 17408
    s_add_u32 s41, s41, 8192
    buffer_load_dwordx4 v3, s[24:27], s41 offen lds
    s_waitcnt vmcnt(28)
    ds_read_b64_tr_b16 v[24:25], v4 offset:2048
    ds_read_b64_tr_b16 v[26:27], v4 offset:3072
    ds_read_b64_tr_b16 v[28:29], v5 offset:2048
    ds_read_b64_tr_b16 v[30:31], v5 offset:3072
    s_waitcnt lgkmcnt(4)
    v_mfma_f32_32x32x16_bf16 v[64:79], v[16:19], a[8:11], v[64:79]
    v_mfma_f32_32x32x16_bf16 v[80:95], v[20:23], a[8:11], v[80:95]
    v_mfma_f32_32x32x16_bf16 v[96:111], v[16:19], a[12:15], v[96:111]
    v_mfma_f32_32x32x16_bf16 v[112:127], v[20:23], a[12:15], v[112:127]
    s_add_u32 s41, s48, 19456
    buffer_load_dwordx4 a[8:11], v6, s[20:23], s41 offen
    s_add_u32 s41, s41, 114688
    buffer_load_dwordx4 a[12:15], v6, s[20:23], s41 offen
    s_add_u32 m0, s51, 18432
    s_add_u32 s41, s50, 311296
    buffer_load_dwordx4 v3, s[24:27], s41 offen lds
    s_add_u32 m0, s51, 19456
    s_add_u32 s41, s41, 8192
    buffer_load_dwordx4 v3, s[24:27], s41 offen lds
    s_waitcnt vmcnt(28)
    ds_read_b64_tr_b16 v[16:17], v4 offset:4096
    ds_read_b64_tr_b16 v[18:19], v4 offset:5120
    ds_read_b64_tr_b16 v[20:21], v5 offset:4096
    ds_read_b64_tr_b16 v[22:23], v5 offset:5120
    s_waitcnt lgkmcnt(4)
    v_mfma_f32_32x32x16_bf16 v[64:79], v[24:27], a[16:19], v[64:79]
    v_mfma_f32_32x32x16_bf16 v[80:95], v[28:31], a[16:19], v[80:95]
    v_mfma_f32_32x32x16_bf16 v[96:111], v[24:27], a[20:23], v[96:111]
    v_mfma_f32_32x32x16_bf16 v[112:127], v[28:31], a[20:23], v[112:127]
    v_cvt_pk_bf16_f32 v192, v128, v129
    v_cvt_pk_bf16_f32 v193, v130, v131
    v_cvt_pk_bf16_f32 v194, v132, v133
    v_cvt_pk_bf16_f32 v195, v134, v135
    v_cvt_pk_bf16_f32 v196, v136, v137
    v_cvt_pk_bf16_f32 v197, v138, v139
    v_cvt_pk_bf16_f32 v198, v140, v141
    v_cvt_pk_bf16_f32 v199, v142, v143
    v_cvt_pk_bf16_f32 v200, v144, v145
    v_cvt_pk_bf16_f32 v201, v146, v147
    v_cvt_pk_bf16_f32 v202, v148, v149
    v_cvt_pk_bf16_f32 v203, v150, v151
    v_cvt_pk_bf16_f32 v204, v152, v153
    v_cvt_pk_bf16_f32 v205, v154, v155
    v_cvt_pk_bf16_f32 v206, v156, v157
    v_cvt_pk_bf16_f32 v207, v158, v159
    v_cvt_pk_bf16_f32 v208, v160, v161
    v_cvt_pk_bf16_f32 v209, v162, v163
    v_cvt_pk_bf16_f32 v210, v164, v165
    v_cvt_pk_bf16_f32 v211, v166, v167
    v_cvt_pk_bf16_f32 v212, v168, v169
    v_cvt_pk_bf16_f32 v213, v170, v171
    v_cvt_pk_bf16_f32 v214, v172, v173
    v_cvt_pk_bf16_f32 v215, v174, v175
    v_cvt_pk_bf16_f32 v216, v176, v177
    v_cvt_pk_bf16_f32 v217, v178, v179
    v_cvt_pk_bf16_f32 v218, v180, v181
    v_cvt_pk_bf16_f32 v219, v182, v183
    v_cvt_pk_bf16_f32 v220, v184, v185
    v_cvt_pk_bf16_f32 v221, v186, v187
    v_cvt_pk_bf16_f32 v222, v188, v189
    v_cvt_pk_bf16_f32 v223, v190, v191
    s_add_u32 s41, s48, 20480
    buffer_load_dwordx4 a[16:19], v6, s[20:23], s41 offen
    s_add_u32 s41, s41, 114688
    buffer_load_dwordx4 a[20:23], v6, s[20:23], s41 offen
    s_add_u32 m0, s51, 0
    s_add_u32 s41, s50, 327680
    buffer_load_dwordx4 v3, s[24:27], s41 offen lds
    s_add_u32 m0, s51, 1024
    s_add_u32 s41, s41, 8192
    buffer_load_dwordx4 v3, s[24:27], s41 offen lds
    s_waitcnt vmcnt(28)
    ds_read_b64_tr_b16 v[24:25], v4 offset:6144
    ds_read_b64_tr_b16 v[26:27], v4 offset:7168
    ds_read_b64_tr_b16 v[28:29], v5 offset:6144
    ds_read_b64_tr_b16 v[30:31], v5 offset:7168
    s_waitcnt lgkmcnt(4)
    v_mfma_f32_32x32x16_bf16 v[64:79], v[16:19], a[24:27], v[64:79]
    v_mfma_f32_32x32x16_bf16 v[80:95], v[20:23], a[24:27], v[80:95]
    v_mfma_f32_32x32x16_bf16 v[96:111], v[16:19], a[28:31], v[96:111]
    v_mfma_f32_32x32x16_bf16 v[112:127], v[20:23], a[28:31], v[112:127]
    s_add_u32 s41, s48, 21504
    buffer_load_dwordx4 a[24:27], v6, s[20:23], s41 offen
    s_add_u32 s41, s41, 114688
    buffer_load_dwordx4 a[28:31], v6, s[20:23], s41 offen
    s_add_u32 m0, s51, 2048
    s_add_u32 s41, s50, 344064
    buffer_load_dwordx4 v3, s[24:27], s41 offen lds
    s_add_u32 m0, s51, 3072
    s_add_u32 s41, s41, 8192
    buffer_load_dwordx4 v3, s[24:27], s41 offen lds
    s_waitcnt vmcnt(28)
    ds_read_b64_tr_b16 v[16:17], v4 offset:8192
    ds_read_b64_tr_b16 v[18:19], v4 offset:9216
    ds_read_b64_tr_b16 v[20:21], v5 offset:8192
    ds_read_b64_tr_b16 v[22:23], v5 offset:9216
    s_waitcnt lgkmcnt(4)
    v_mfma_f32_32x32x16_bf16 v[64:79], v[24:27], a[32:35], v[64:79]
    v_mfma_f32_32x32x16_bf16 v[80:95], v[28:31], a[32:35], v[80:95]
    v_mfma_f32_32x32x16_bf16 v[96:111], v[24:27], a[36:39], v[96:111]
    v_mfma_f32_32x32x16_bf16 v[112:127], v[28:31], a[36:39], v[112:127]
    s_add_u32 s41, s48, 22528
    buffer_load_dwordx4 a[32:35], v6, s[20:23], s41 offen
    s_add_u32 s41, s41, 114688
    buffer_load_dwordx4 a[36:39], v6, s[20:23], s41 offen
    s_add_u32 m0, s51, 4096
    s_add_u32 s41, s50, 360448
    buffer_load_dwordx4 v3, s[24:27], s41 offen lds
    s_add_u32 m0, s51, 5120
    s_add_u32 s41, s41, 8192
    buffer_load_dwordx4 v3, s[24:27], s41 offen lds
    s_waitcnt vmcnt(28)
    ds_read_b64_tr_b16 v[24:25], v4 offset:10240
    ds_read_b64_tr_b16 v[26:27], v4 offset:11264
    ds_read_b64_tr_b16 v[28:29], v5 offset:10240
    ds_read_b64_tr_b16 v[30:31], v5 offset:11264
    s_waitcnt lgkmcnt(4)
    v_mfma_f32_32x32x16_bf16 v[64:79], v[16:19], a[40:43], v[64:79]
    v_mfma_f32_32x32x16_bf16 v[80:95], v[20:23], a[40:43], v[80:95]
    v_mfma_f32_32x32x16_bf16 v[96:111], v[16:19], a[44:47], v[96:111]
    v_mfma_f32_32x32x16_bf16 v[112:127], v[20:23], a[44:47], v[112:127]
    s_add_u32 s41, s48, 23552
    buffer_load_dwordx4 a[40:43], v6, s[20:23], s41 offen
    s_add_u32 s41, s41, 114688
    buffer_load_dwordx4 a[44:47], v6, s[20:23], s41 offen
    s_add_u32 m0, s51, 6144
    s_add_u32 s41, s50, 376832
    buffer_load_dwordx4 v3, s[24:27], s41 offen lds
    s_add_u32 m0, s51, 7168
    s_add_u32 s41, s41, 8192
    buffer_load_dwordx4 v3, s[24:27], s41 offen lds
    s_waitcnt vmcnt(28)
    ds_read_b64_tr_b16 v[16:17], v4 offset:12288
    ds_read_b64_tr_b16 v[18:19], v4 offset:13312
    ds_read_b64_tr_b16 v[20:21], v5 offset:12288
    ds_read_b64_tr_b16 v[22:23], v5 offset:13312
    s_waitcnt lgkmcnt(4)
    v_mfma_f32_32x32x16_bf16 v[64:79], v[24:27], a[48:51], v[64:79]
    v_mfma_f32_32x32x16_bf16 v[80:95], v[28:31], a[48:51], v[80:95]
    v_mfma_f32_32x32x16_bf16 v[96:111], v[24:27], a[52:55], v[96:111]
    v_mfma_f32_32x32x16_bf16 v[112:127], v[28:31], a[52:55], v[112:127]
    s_add_u32 s41, s48, 24576
    buffer_load_dwordx4 a[48:51], v6, s[20:23], s41 offen
    s_add_u32 s41, s41, 114688
    buffer_load_dwordx4 a[52:55], v6, s[20:23], s41 offen
    s_add_u32 m0, s51, 8192
    s_add_u32 s41, s50, 393216
    buffer_load_dwordx4 v3, s[24:27], s41 offen lds
    s_add_u32 m0, s51, 9216
    s_add_u32 s41, s41, 8192
    buffer_load_dwordx4 v3, s[24:27], s41 offen lds
    s_waitcnt vmcnt(28)
    ds_read_b64_tr_b16 v[24:25], v4 offset:14336
    ds_read_b64_tr_b16 v[26:27], v4 offset:15360
    ds_read_b64_tr_b16 v[28:29], v5 offset:14336
    ds_read_b64_tr_b16 v[30:31], v5 offset:15360
    s_waitcnt lgkmcnt(4)
    v_mfma_f32_32x32x16_bf16 v[64:79], v[16:19], a[56:59], v[64:79]
    v_mfma_f32_32x32x16_bf16 v[80:95], v[20:23], a[56:59], v[80:95]
    v_mfma_f32_32x32x16_bf16 v[96:111], v[16:19], a[60:63], v[96:111]
    v_mfma_f32_32x32x16_bf16 v[112:127], v[20:23], a[60:63], v[112:127]
    s_add_u32 s41, s48, 25600
    buffer_load_dwordx4 a[56:59], v6, s[20:23], s41 offen
    s_add_u32 s41, s41, 114688
    buffer_load_dwordx4 a[60:63], v6, s[20:23], s41 offen
    s_add_u32 m0, s51, 10240
    s_add_u32 s41, s50, 409600
    buffer_load_dwordx4 v3, s[24:27], s41 offen lds
    s_add_u32 m0, s51, 11264
    s_add_u32 s41, s41, 8192
    buffer_load_dwordx4 v3, s[24:27], s41 offen lds
    s_waitcnt vmcnt(28)
    ds_read_b64_tr_b16 v[16:17], v4 offset:16384
    ds_read_b64_tr_b16 v[18:19], v4 offset:17408
    ds_read_b64_tr_b16 v[20:21], v5 offset:16384
    ds_read_b64_tr_b16 v[22:23], v5 offset:17408
    s_waitcnt lgkmcnt(4)
    v_mfma_f32_32x32x16_bf16 v[64:79], v[24:27], a[64:67], v[64:79]
    v_mfma_f32_32x32x16_bf16 v[80:95], v[28:31], a[64:67], v[80:95]
    v_mfma_f32_32x32x16_bf16 v[96:111], v[24:27], a[68:71], v[96:111]
    v_mfma_f32_32x32x16_bf16 v[112:127], v[28:31], a[68:71], v[112:127]
    s_add_u32 s41, s48, 26624
    buffer_load_dwordx4 a[64:67], v6, s[20:23], s41 offen
    s_add_u32 s41, s41, 114688
    buffer_load_dwordx4 a[68:71], v6, s[20:23], s41 offen
    s_add_u32 m0, s51, 12288
    s_add_u32 s41, s50, 425984
    buffer_load_dwordx4 v3, s[24:27], s41 offen lds
    s_add_u32 m0, s51, 13312
    s_add_u32 s41, s41, 8192
    buffer_load_dwordx4 v3, s[24:27], s41 offen lds
    s_waitcnt vmcnt(28)
    ds_read_b64_tr_b16 v[24:25], v4 offset:18432
    ds_read_b64_tr_b16 v[26:27], v4 offset:19456
    ds_read_b64_tr_b16 v[28:29], v5 offset:18432
    ds_read_b64_tr_b16 v[30:31], v5 offset:19456
    s_waitcnt lgkmcnt(4)
    v_mfma_f32_32x32x16_bf16 v[64:79], v[16:19], a[0:3], v[64:79]
    v_mfma_f32_32x32x16_bf16 v[80:95], v[20:23], a[0:3], v[80:95]
    v_mfma_f32_32x32x16_bf16 v[96:111], v[16:19], a[4:7], v[96:111]
    v_mfma_f32_32x32x16_bf16 v[112:127], v[20:23], a[4:7], v[112:127]
    s_add_u32 s41, s48, 27648
    buffer_load_dwordx4 a[0:3], v6, s[20:23], s41 offen
    s_add_u32 s41, s41, 114688
    buffer_load_dwordx4 a[4:7], v6, s[20:23], s41 offen
    s_add_u32 m0, s51, 14336
    s_add_u32 s41, s50, 442368
    buffer_load_dwordx4 v3, s[24:27], s41 offen lds
    s_add_u32 m0, s51, 15360
    s_add_u32 s41, s41, 8192
    buffer_load_dwordx4 v3, s[24:27], s41 offen lds
    s_waitcnt vmcnt(28)
    ds_read_b64_tr_b16 v[16:17], v4 offset:0
    ds_read_b64_tr_b16 v[18:19], v4 offset:1024
    ds_read_b64_tr_b16 v[20:21], v5 offset:0
    ds_read_b64_tr_b16 v[22:23], v5 offset:1024
    s_waitcnt lgkmcnt(4)
    v_mfma_f32_32x32x16_bf16 v[64:79], v[24:27], a[8:11], v[64:79]
    v_mfma_f32_32x32x16_bf16 v[80:95], v[28:31], a[8:11], v[80:95]
    v_mfma_f32_32x32x16_bf16 v[96:111], v[24:27], a[12:15], v[96:111]
    v_mfma_f32_32x32x16_bf16 v[112:127], v[28:31], a[12:15], v[112:127]
    s_add_u32 s41, s52, 0
    buffer_load_dwordx4 a[8:11], v6, s[20:23], s41 offen
    s_add_u32 s41, s41, 32768
    buffer_load_dwordx4 a[12:15], v6, s[20:23], s41 offen
    s_add_u32 m0, s51, 16384
    s_add_u32 s41, s55, 0
    buffer_load_dwordx4 v3, s[28:31], s41 offen lds
    s_add_u32 m0, s51, 17408
    s_add_u32 s41, s41, 8192
    buffer_load_dwordx4 v3, s[28:31], s41 offen lds
    s_waitcnt vmcnt(28)
    ds_read_b64_tr_b16 v[24:25], v4 offset:2048
    ds_read_b64_tr_b16 v[26:27], v4 offset:3072
    ds_read_b64_tr_b16 v[28:29], v5 offset:2048
    ds_read_b64_tr_b16 v[30:31], v5 offset:3072
    s_waitcnt lgkmcnt(4)
    v_mfma_f32_32x32x16_bf16 v[64:79], v[16:19], a[16:19], v[64:79]
    v_mfma_f32_32x32x16_bf16 v[80:95], v[20:23], a[16:19], v[80:95]
    v_mfma_f32_32x32x16_bf16 v[96:111], v[16:19], a[20:23], v[96:111]
    v_mfma_f32_32x32x16_bf16 v[112:127], v[20:23], a[20:23], v[112:127]
    s_add_u32 s41, s52, 1024
    buffer_load_dwordx4 a[16:19], v6, s[20:23], s41 offen
    s_add_u32 s41, s41, 32768
    buffer_load_dwordx4 a[20:23], v6, s[20:23], s41 offen
    s_add_u32 m0, s51, 18432
    s_add_u32 s41, s55, 16384
    buffer_load_dwordx4 v3, s[28:31], s41 offen lds
    s_add_u32 m0, s51, 19456
    s_add_u32 s41, s41, 8192
    buffer_load_dwordx4 v3, s[28:31], s41 offen lds
    s_waitcnt vmcnt(28)
    ds_read_b64_tr_b16 v[16:17], v4 offset:4096
    ds_read_b64_tr_b16 v[18:19], v4 offset:5120
    ds_read_b64_tr_b16 v[20:21], v5 offset:4096
    ds_read_b64_tr_b16 v[22:23], v5 offset:5120
    s_waitcnt lgkmcnt(4)
    v_mfma_f32_32x32x16_bf16 v[64:79], v[24:27], a[24:27], v[64:79]
    v_mfma_f32_32x32x16_bf16 v[80:95], v[28:31], a[24:27], v[80:95]
    v_mfma_f32_32x32x16_bf16 v[96:111], v[24:27], a[28:31], v[96:111]
    v_mfma_f32_32x32x16_bf16 v[112:127], v[28:31], a[28:31], v[112:127]
    s_add_u32 s41, s52, 2048
    buffer_load_dwordx4 a[24:27], v6, s[20:23], s41 offen
    s_add_u32 s41, s41, 32768
    buffer_load_dwordx4 a[28:31], v6, s[20:23], s41 offen
    s_add_u32 m0, s51, 0
    s_add_u32 s41, s55, 32768
    buffer_load_dwordx4 v3, s[28:31], s41 offen lds
    s_add_u32 m0, s51, 1024
    s_add_u32 s41, s41, 8192
    buffer_load_dwordx4 v3, s[28:31], s41 offen lds
    s_waitcnt vmcnt(28)
    ds_read_b64_tr_b16 v[24:25], v4 offset:6144
    ds_read_b64_tr_b16 v[26:27], v4 offset:7168
    ds_read_b64_tr_b16 v[28:29], v5 offset:6144
    ds_read_b64_tr_b16 v[30:31], v5 offset:7168
    s_waitcnt lgkmcnt(4)
    v_mfma_f32_32x32x16_bf16 v[64:79], v[16:19], a[32:35], v[64:79]
    v_mfma_f32_32x32x16_bf16 v[80:95], v[20:23], a[32:35], v[80:95]
    v_mfma_f32_32x32x16_bf16 v[96:111], v[16:19], a[36:39], v[96:111]
    v_mfma_f32_32x32x16_bf16 v[112:127], v[20:23], a[36:39], v[112:127]
    s_add_u32 s41, s52, 3072
    buffer_load_dwordx4 a[32:35], v6, s[20:23], s41 offen
    s_add_u32 s41, s41, 32768
    buffer_load_dwordx4 a[36:39], v6, s[20:23], s41 offen
    s_add_u32 m0, s51, 2048
    s_add_u32 s41, s55, 49152
    buffer_load_dwordx4 v3, s[28:31], s41 offen lds
    s_add_u32 m0, s51, 3072
    s_add_u32 s41, s41, 8192
    buffer_load_dwordx4 v3, s[28:31], s41 offen lds
    s_waitcnt vmcnt(28)
    ds_read_b64_tr_b16 v[16:17], v4 offset:8192
    ds_read_b64_tr_b16 v[18:19], v4 offset:9216
    ds_read_b64_tr_b16 v[20:21], v5 offset:8192
    ds_read_b64_tr_b16 v[22:23], v5 offset:9216
    s_waitcnt lgkmcnt(4)
    v_mfma_f32_32x32x16_bf16 v[64:79], v[24:27], a[40:43], v[64:79]
    v_mfma_f32_32x32x16_bf16 v[80:95], v[28:31], a[40:43], v[80:95]
    v_mfma_f32_32x32x16_bf16 v[96:111], v[24:27], a[44:47], v[96:111]
    v_mfma_f32_32x32x16_bf16 v[112:127], v[28:31], a[44:47], v[112:127]
    s_add_u32 s41, s52, 4096
    buffer_load_dwordx4 a[40:43], v6, s[20:23], s41 offen
    s_add_u32 s41, s41, 32768
    buffer_load_dwordx4 a[44:47], v6, s[20:23], s41 offen
    s_add_u32 m0, s51, 4096
    s_add_u32 s41, s55, 65536
    buffer_load_dwordx4 v3, s[28:31], s41 offen lds
    s_add_u32 m0, s51, 5120
    s_add_u32 s41, s41, 8192
    buffer_load_dwordx4 v3, s[28:31], s41 offen lds
    s_waitcnt vmcnt(28)
    ds_read_b64_tr_b16 v[24:25], v4 offset:10240
    ds_read_b64_tr_b16 v[26:27], v4 offset:11264
    ds_read_b64_tr_b16 v[28:29], v5 offset:10240
    ds_read_b64_tr_b16 v[30:31], v5 offset:11264
    s_waitcnt lgkmcnt(4)
    v_mfma_f32_32x32x16_bf16 v[64:79], v[16:19], a[48:51], v[64:79]
    v_mfma_f32_32x32x16_bf16 v[80:95], v[20:23], a[48:51], v[80:95]
    v_mfma_f32_32x32x16_bf16 v[96:111], v[16:19], a[52:55], v[96:111]
    v_mfma_f32_32x32x16_bf16 v[112:127], v[20:23], a[52:55], v[112:127]
    s_add_u32 s41, s52, 5120
    buffer_load_dwordx4 a[48:51], v6, s[20:23], s41 offen
    s_add_u32 s41, s41, 32768
    buffer_load_dwordx4 a[52:55], v6, s[20:23], s41 offen
    s_add_u32 m0, s51, 6144
    s_add_u32 s41, s55, 81920
    buffer_load_dwordx4 v3, s[28:31], s41 offen lds
    s_add_u32 m0, s51, 7168
    s_add_u32 s41, s41, 8192
    buffer_load_dwordx4 v3, s[28:31], s41 offen lds
    s_waitcnt vmcnt(28)
    ds_read_b64_tr_b16 v[16:17], v4 offset:12288
    ds_read_b64_tr_b16 v[18:19], v4 offset:13312
    ds_read_b64_tr_b16 v[20:21], v5 offset:12288
    ds_read_b64_tr_b16 v[22:23], v5 offset:13312
    s_waitcnt lgkmcnt(4)
    v_mfma_f32_32x32x16_bf16 v[64:79], v[24:27], a[56:59], v[64:79]
    v_mfma_f32_32x32x16_bf16 v[80:95], v[28:31], a[56:59], v[80:95]
    v_mfma_f32_32x32x16_bf16 v[96:111], v[24:27], a[60:63], v[96:111]
    v_mfma_f32_32x32x16_bf16 v[112:127], v[28:31], a[60:63], v[112:127]
    s_add_u32 s41, s52, 6144
    buffer_load_dwordx4 a[56:59], v6, s[20:23], s41 offen
    s_add_u32 s41, s41, 32768
    buffer_load_dwordx4 a[60:63], v6, s[20:23], s41 offen
    s_add_u32 m0, s51, 8192
    s_add_u32 s41, s55, 98304
    buffer_load_dwordx4 v3, s[28:31], s41 offen lds
    s_add_u32 m0, s51, 9216
    s_add_u32 s41, s41, 8192
    buffer_load_dwordx4 v3, s[28:31], s41 offen lds
    s_waitcnt vmcnt(28)
    ds_read_b64_tr_b16 v[24:25], v4 offset:14336
    ds_read_b64_tr_b16 v[26:27], v4 offset:15360
    ds_read_b64_tr_b16 v[28:29], v5 offset:14336
    ds_read_b64_tr_b16 v[30:31], v5 offset:15360
    s_waitcnt lgkmcnt(4)
    v_mfma_f32_32x32x16_bf16 v[64:79], v[16:19], a[64:67], v[64:79]
    v_mfma_f32_32x32x16_bf16 v[80:95], v[20:23], a[64:67], v[80:95]
    v_mfma_f32_32x32x16_bf16 v[96:111], v[16:19], a[68:71], v[96:111]
    v_mfma_f32_32x32x16_bf16 v[112:127], v[20:23], a[68:71], v[112:127]
    s_add_u32 s41, s52, 7168
    buffer_load_dwordx4 a[64:67], v6, s[20:23], s41 offen
    s_add_u32 s41, s41, 32768
    buffer_load_dwordx4 a[68:71], v6, s[20:23], s41 offen
    s_add_u32 m0, s51, 10240
    s_add_u32 s41, s55, 114688
    buffer_load_dwordx4 v3, s[28:31], s41 offen lds
    s_add_u32 m0, s51, 11264
    s_add_u32 s41, s41, 8192
    buffer_load_dwordx4 v3, s[28:31], s41 offen lds
    s_waitcnt vmcnt(28)
    ds_read_b64_tr_b16 v[16:17], v4 offset:16384
    ds_read_b64_tr_b16 v[18:19], v4 offset:17408
    ds_read_b64_tr_b16 v[20:21], v5 offset:16384
    ds_read_b64_tr_b16 v[22:23], v5 offset:17408
    s_waitcnt lgkmcnt(4)
    v_mfma_f32_32x32x16_bf16 v[64:79], v[24:27], a[0:3], v[64:79]
    v_mfma_f32_32x32x16_bf16 v[80:95], v[28:31], a[0:3], v[80:95]
    v_mfma_f32_32x32x16_bf16 v[96:111], v[24:27], a[4:7], v[96:111]
    v_mfma_f32_32x32x16_bf16 v[112:127], v[28:31], a[4:7], v[112:127]
    s_waitcnt vmcnt(24)
    ds_read_b64_tr_b16 v[24:25], v4 offset:18432
    ds_read_b64_tr_b16 v[26:27], v4 offset:19456
    ds_read_b64_tr_b16 v[28:29], v5 offset:18432
    ds_read_b64_tr_b16 v[30:31], v5 offset:19456
    s_waitcnt lgkmcnt(4)
    v_mfma_f32_32x32x16_bf16 v[32:47], v[192:195], a[8:11], 0
    v_mfma_f32_32x32x16_bf16 v[48:63], v[192:195], a[12:15], 0
    s_nop 10
    v_cvt_pk_bf16_f32 v41, v40, v40
    v_lshlrev_b32 v41, 16, v41
    v_add_f32 v41, 0x358637bd, v41
    v_cvt_pk_bf16_f32 v41, v41, v41
    v_lshlrev_b32 v41, 16, v41
    v_rcp_f32 v42, v41
    s_nop 0
    v_fma_f32 v43, -v41, v42, 1.0
    v_fma_f32 v42, v43, v42, v42
    v_cvt_pk_bf16_f32 v44, v32, v33
    v_lshlrev_b32 v45, 16, v44
    v_and_b32 v46, 0xffff0000, v44
    v_mul_f32 v45, v45, v42
    v_mul_f32 v46, v46, v42
    v_cvt_pk_bf16_f32 v224, v45, v46
    v_cvt_pk_bf16_f32 v44, v34, v35
    v_lshlrev_b32 v45, 16, v44
    v_and_b32 v46, 0xffff0000, v44
    v_mul_f32 v45, v45, v42
    v_mul_f32 v46, v46, v42
    v_cvt_pk_bf16_f32 v225, v45, v46
    v_cvt_pk_bf16_f32 v44, v36, v37
    v_lshlrev_b32 v45, 16, v44
    v_and_b32 v46, 0xffff0000, v44
    v_mul_f32 v45, v45, v42
    v_mul_f32 v46, v46, v42
    v_cvt_pk_bf16_f32 v226, v45, v46
    v_cvt_pk_bf16_f32 v44, v38, v39
    v_lshlrev_b32 v45, 16, v44
    v_and_b32 v46, 0xffff0000, v44
    v_mul_f32 v45, v45, v42
    v_mul_f32 v46, v46, v42
    v_cvt_pk_bf16_f32 v227, v45, v46
    v_cvt_pk_bf16_f32 v57, v56, v56
    v_lshlrev_b32 v57, 16, v57
    v_add_f32 v57, 0x358637bd, v57
    v_cvt_pk_bf16_f32 v57, v57, v57
    v_lshlrev_b32 v57, 16, v57
    v_rcp_f32 v58, v57
    s_nop 0
    v_fma_f32 v59, -v57, v58, 1.0
    v_fma_f32 v58, v59, v58, v58
    v_cvt_pk_bf16_f32 v60, v48, v49
    v_lshlrev_b32 v61, 16, v60
    v_and_b32 v62, 0xffff0000, v60
    v_mul_f32 v61, v61, v58
    v_mul_f32 v62, v62, v58
    v_cvt_pk_bf16_f32 v228, v61, v62
    v_cvt_pk_bf16_f32 v60, v50, v51
    v_lshlrev_b32 v61, 16, v60
    v_and_b32 v62, 0xffff0000, v60
    v_mul_f32 v61, v61, v58
    v_mul_f32 v62, v62, v58
    v_cvt_pk_bf16_f32 v229, v61, v62
    v_cvt_pk_bf16_f32 v60, v52, v53
    v_lshlrev_b32 v61, 16, v60
    v_and_b32 v62, 0xffff0000, v60
    v_mul_f32 v61, v61, v58
    v_mul_f32 v62, v62, v58
    v_cvt_pk_bf16_f32 v230, v61, v62
    v_cvt_pk_bf16_f32 v60, v54, v55
    v_lshlrev_b32 v61, 16, v60
    v_and_b32 v62, 0xffff0000, v60
    v_mul_f32 v61, v61, v58
    v_mul_f32 v62, v62, v58
    v_cvt_pk_bf16_f32 v231, v61, v62
    v_mfma_f32_32x32x16_bf16 v[128:143], v[16:19], v[224:227], 0
    v_mfma_f32_32x32x16_bf16 v[144:159], v[20:23], v[224:227], 0
    v_mfma_f32_32x32x16_bf16 v[160:175], v[16:19], v[228:231], 0
    v_mfma_f32_32x32x16_bf16 v[176:191], v[20:23], v[228:231], 0
    s_waitcnt vmcnt(20)
    ds_read_b64_tr_b16 v[16:17], v4 offset:0
    ds_read_b64_tr_b16 v[18:19], v4 offset:1024
    ds_read_b64_tr_b16 v[20:21], v5 offset:0
    ds_read_b64_tr_b16 v[22:23], v5 offset:1024
    s_waitcnt lgkmcnt(4)
    v_mfma_f32_32x32x16_bf16 v[32:47], v[196:199], a[16:19], 0
    v_mfma_f32_32x32x16_bf16 v[48:63], v[196:199], a[20:23], 0
    s_nop 10
    v_cvt_pk_bf16_f32 v41, v40, v40
    v_lshlrev_b32 v41, 16, v41
    v_add_f32 v41, 0x358637bd, v41
    v_cvt_pk_bf16_f32 v41, v41, v41
    v_lshlrev_b32 v41, 16, v41
    v_rcp_f32 v42, v41
    s_nop 0
    v_fma_f32 v43, -v41, v42, 1.0
    v_fma_f32 v42, v43, v42, v42
    v_cvt_pk_bf16_f32 v44, v32, v33
    v_lshlrev_b32 v45, 16, v44
    v_and_b32 v46, 0xffff0000, v44
    v_mul_f32 v45, v45, v42
    v_mul_f32 v46, v46, v42
    v_cvt_pk_bf16_f32 v224, v45, v46
    v_cvt_pk_bf16_f32 v44, v34, v35
    v_lshlrev_b32 v45, 16, v44
    v_and_b32 v46, 0xffff0000, v44
    v_mul_f32 v45, v45, v42
    v_mul_f32 v46, v46, v42
    v_cvt_pk_bf16_f32 v225, v45, v46
    v_cvt_pk_bf16_f32 v44, v36, v37
    v_lshlrev_b32 v45, 16, v44
    v_and_b32 v46, 0xffff0000, v44
    v_mul_f32 v45, v45, v42
    v_mul_f32 v46, v46, v42
    v_cvt_pk_bf16_f32 v226, v45, v46
    v_cvt_pk_bf16_f32 v44, v38, v39
    v_lshlrev_b32 v45, 16, v44
    v_and_b32 v46, 0xffff0000, v44
    v_mul_f32 v45, v45, v42
    v_mul_f32 v46, v46, v42
    v_cvt_pk_bf16_f32 v227, v45, v46
    v_cvt_pk_bf16_f32 v57, v56, v56
    v_lshlrev_b32 v57, 16, v57
    v_add_f32 v57, 0x358637bd, v57
    v_cvt_pk_bf16_f32 v57, v57, v57
    v_lshlrev_b32 v57, 16, v57
    v_rcp_f32 v58, v57
    s_nop 0
    v_fma_f32 v59, -v57, v58, 1.0
    v_fma_f32 v58, v59, v58, v58
    v_cvt_pk_bf16_f32 v60, v48, v49
    v_lshlrev_b32 v61, 16, v60
    v_and_b32 v62, 0xffff0000, v60
    v_mul_f32 v61, v61, v58
    v_mul_f32 v62, v62, v58
    v_cvt_pk_bf16_f32 v228, v61, v62
    v_cvt_pk_bf16_f32 v60, v50, v51
    v_lshlrev_b32 v61, 16, v60
    v_and_b32 v62, 0xffff0000, v60
    v_mul_f32 v61, v61, v58
    v_mul_f32 v62, v62, v58
    v_cvt_pk_bf16_f32 v229, v61, v62
    v_cvt_pk_bf16_f32 v60, v52, v53
    v_lshlrev_b32 v61, 16, v60
    v_and_b32 v62, 0xffff0000, v60
    v_mul_f32 v61, v61, v58
    v_mul_f32 v62, v62, v58
    v_cvt_pk_bf16_f32 v230, v61, v62
    v_cvt_pk_bf16_f32 v60, v54, v55
    v_lshlrev_b32 v61, 16, v60
    v_and_b32 v62, 0xffff0000, v60
    v_mul_f32 v61, v61, v58
    v_mul_f32 v62, v62, v58
    v_cvt_pk_bf16_f32 v231, v61, v62
    v_mfma_f32_32x32x16_bf16 v[128:143], v[24:27], v[224:227], v[128:143]
    v_mfma_f32_32x32x16_bf16 v[144:159], v[28:31], v[224:227], v[144:159]
    v_mfma_f32_32x32x16_bf16 v[160:175], v[24:27], v[228:231], v[160:175]
    v_mfma_f32_32x32x16_bf16 v[176:191], v[28:31], v[228:231], v[176:191]
    s_waitcnt vmcnt(16)
    ds_read_b64_tr_b16 v[24:25], v4 offset:2048
    ds_read_b64_tr_b16 v[26:27], v4 offset:3072
    ds_read_b64_tr_b16 v[28:29], v5 offset:2048
    ds_read_b64_tr_b16 v[30:31], v5 offset:3072
    s_waitcnt lgkmcnt(4)
    v_mfma_f32_32x32x16_bf16 v[32:47], v[200:203], a[24:27], 0
    v_mfma_f32_32x32x16_bf16 v[48:63], v[200:203], a[28:31], 0
    s_nop 10
    v_cvt_pk_bf16_f32 v41, v40, v40
    v_lshlrev_b32 v41, 16, v41
    v_add_f32 v41, 0x358637bd, v41
    v_cvt_pk_bf16_f32 v41, v41, v41
    v_lshlrev_b32 v41, 16, v41
    v_rcp_f32 v42, v41
    s_nop 0
    v_fma_f32 v43, -v41, v42, 1.0
    v_fma_f32 v42, v43, v42, v42
    v_cvt_pk_bf16_f32 v44, v32, v33
    v_lshlrev_b32 v45, 16, v44
    v_and_b32 v46, 0xffff0000, v44
    v_mul_f32 v45, v45, v42
    v_mul_f32 v46, v46, v42
    v_cvt_pk_bf16_f32 v224, v45, v46
    v_cvt_pk_bf16_f32 v44, v34, v35
    v_lshlrev_b32 v45, 16, v44
    v_and_b32 v46, 0xffff0000, v44
    v_mul_f32 v45, v45, v42
    v_mul_f32 v46, v46, v42
    v_cvt_pk_bf16_f32 v225, v45, v46
    v_cvt_pk_bf16_f32 v44, v36, v37
    v_lshlrev_b32 v45, 16, v44
    v_and_b32 v46, 0xffff0000, v44
    v_mul_f32 v45, v45, v42
    v_mul_f32 v46, v46, v42
    v_cvt_pk_bf16_f32 v226, v45, v46
    v_cvt_pk_bf16_f32 v44, v38, v39
    v_lshlrev_b32 v45, 16, v44
    v_and_b32 v46, 0xffff0000, v44
    v_mul_f32 v45, v45, v42
    v_mul_f32 v46, v46, v42
    v_cvt_pk_bf16_f32 v227, v45, v46
    v_cvt_pk_bf16_f32 v57, v56, v56
    v_lshlrev_b32 v57, 16, v57
    v_add_f32 v57, 0x358637bd, v57
    v_cvt_pk_bf16_f32 v57, v57, v57
    v_lshlrev_b32 v57, 16, v57
    v_rcp_f32 v58, v57
    s_nop 0
    v_fma_f32 v59, -v57, v58, 1.0
    v_fma_f32 v58, v59, v58, v58
    v_cvt_pk_bf16_f32 v60, v48, v49
    v_lshlrev_b32 v61, 16, v60
    v_and_b32 v62, 0xffff0000, v60
    v_mul_f32 v61, v61, v58
    v_mul_f32 v62, v62, v58
    v_cvt_pk_bf16_f32 v228, v61, v62
    v_cvt_pk_bf16_f32 v60, v50, v51
    v_lshlrev_b32 v61, 16, v60
    v_and_b32 v62, 0xffff0000, v60
    v_mul_f32 v61, v61, v58
    v_mul_f32 v62, v62, v58
    v_cvt_pk_bf16_f32 v229, v61, v62
    v_cvt_pk_bf16_f32 v60, v52, v53
    v_lshlrev_b32 v61, 16, v60
    v_and_b32 v62, 0xffff0000, v60
    v_mul_f32 v61, v61, v58
    v_mul_f32 v62, v62, v58
    v_cvt_pk_bf16_f32 v230, v61, v62
    v_cvt_pk_bf16_f32 v60, v54, v55
    v_lshlrev_b32 v61, 16, v60
    v_and_b32 v62, 0xffff0000, v60
    v_mul_f32 v61, v61, v58
    v_mul_f32 v62, v62, v58
    v_cvt_pk_bf16_f32 v231, v61, v62
    v_mfma_f32_32x32x16_bf16 v[128:143], v[16:19], v[224:227], v[128:143]
    v_mfma_f32_32x32x16_bf16 v[144:159], v[20:23], v[224:227], v[144:159]
    v_mfma_f32_32x32x16_bf16 v[160:175], v[16:19], v[228:231], v[160:175]
    v_mfma_f32_32x32x16_bf16 v[176:191], v[20:23], v[228:231], v[176:191]
    s_waitcnt vmcnt(12)
    ds_read_b64_tr_b16 v[16:17], v4 offset:4096
    ds_read_b64_tr_b16 v[18:19], v4 offset:5120
    ds_read_b64_tr_b16 v[20:21], v5 offset:4096
    ds_read_b64_tr_b16 v[22:23], v5 offset:5120
    s_waitcnt lgkmcnt(4)
    v_mfma_f32_32x32x16_bf16 v[32:47], v[204:207], a[32:35], 0
    v_mfma_f32_32x32x16_bf16 v[48:63], v[204:207], a[36:39], 0
    s_nop 10
    v_cvt_pk_bf16_f32 v41, v40, v40
    v_lshlrev_b32 v41, 16, v41
    v_add_f32 v41, 0x358637bd, v41
    v_cvt_pk_bf16_f32 v41, v41, v41
    v_lshlrev_b32 v41, 16, v41
    v_rcp_f32 v42, v41
    s_nop 0
    v_fma_f32 v43, -v41, v42, 1.0
    v_fma_f32 v42, v43, v42, v42
    v_cvt_pk_bf16_f32 v44, v32, v33
    v_lshlrev_b32 v45, 16, v44
    v_and_b32 v46, 0xffff0000, v44
    v_mul_f32 v45, v45, v42
    v_mul_f32 v46, v46, v42
    v_cvt_pk_bf16_f32 v224, v45, v46
    v_cvt_pk_bf16_f32 v44, v34, v35
    v_lshlrev_b32 v45, 16, v44
    v_and_b32 v46, 0xffff0000, v44
    v_mul_f32 v45, v45, v42
    v_mul_f32 v46, v46, v42
    v_cvt_pk_bf16_f32 v225, v45, v46
    v_cvt_pk_bf16_f32 v44, v36, v37
    v_lshlrev_b32 v45, 16, v44
    v_and_b32 v46, 0xffff0000, v44
    v_mul_f32 v45, v45, v42
    v_mul_f32 v46, v46, v42
    v_cvt_pk_bf16_f32 v226, v45, v46
    v_cvt_pk_bf16_f32 v44, v38, v39
    v_lshlrev_b32 v45, 16, v44
    v_and_b32 v46, 0xffff0000, v44
    v_mul_f32 v45, v45, v42
    v_mul_f32 v46, v46, v42
    v_cvt_pk_bf16_f32 v227, v45, v46
    v_cvt_pk_bf16_f32 v57, v56, v56
    v_lshlrev_b32 v57, 16, v57
    v_add_f32 v57, 0x358637bd, v57
    v_cvt_pk_bf16_f32 v57, v57, v57
    v_lshlrev_b32 v57, 16, v57
    v_rcp_f32 v58, v57
    s_nop 0
    v_fma_f32 v59, -v57, v58, 1.0
    v_fma_f32 v58, v59, v58, v58
    v_cvt_pk_bf16_f32 v60, v48, v49
    v_lshlrev_b32 v61, 16, v60
    v_and_b32 v62, 0xffff0000, v60
    v_mul_f32 v61, v61, v58
    v_mul_f32 v62, v62, v58
    v_cvt_pk_bf16_f32 v228, v61, v62
    v_cvt_pk_bf16_f32 v60, v50, v51
    v_lshlrev_b32 v61, 16, v60
    v_and_b32 v62, 0xffff0000, v60
    v_mul_f32 v61, v61, v58
    v_mul_f32 v62, v62, v58
    v_cvt_pk_bf16_f32 v229, v61, v62
    v_cvt_pk_bf16_f32 v60, v52, v53
    v_lshlrev_b32 v61, 16, v60
    v_and_b32 v62, 0xffff0000, v60
    v_mul_f32 v61, v61, v58
    v_mul_f32 v62, v62, v58
    v_cvt_pk_bf16_f32 v230, v61, v62
    v_cvt_pk_bf16_f32 v60, v54, v55
    v_lshlrev_b32 v61, 16, v60
    v_and_b32 v62, 0xffff0000, v60
    v_mul_f32 v61, v61, v58
    v_mul_f32 v62, v62, v58
    v_cvt_pk_bf16_f32 v231, v61, v62
    v_mfma_f32_32x32x16_bf16 v[128:143], v[24:27], v[224:227], v[128:143]
    v_mfma_f32_32x32x16_bf16 v[144:159], v[28:31], v[224:227], v[144:159]
    v_mfma_f32_32x32x16_bf16 v[160:175], v[24:27], v[228:231], v[160:175]
    v_mfma_f32_32x32x16_bf16 v[176:191], v[28:31], v[228:231], v[176:191]
    s_waitcnt vmcnt(8)
    ds_read_b64_tr_b16 v[24:25], v4 offset:6144
    ds_read_b64_tr_b16 v[26:27], v4 offset:7168
    ds_read_b64_tr_b16 v[28:29], v5 offset:6144
    ds_read_b64_tr_b16 v[30:31], v5 offset:7168
    s_waitcnt lgkmcnt(4)
    v_mfma_f32_32x32x16_bf16 v[32:47], v[208:211], a[40:43], 0
    v_mfma_f32_32x32x16_bf16 v[48:63], v[208:211], a[44:47], 0
    s_nop 10
    v_cvt_pk_bf16_f32 v41, v40, v40
    v_lshlrev_b32 v41, 16, v41
    v_add_f32 v41, 0x358637bd, v41
    v_cvt_pk_bf16_f32 v41, v41, v41
    v_lshlrev_b32 v41, 16, v41
    v_rcp_f32 v42, v41
    s_nop 0
    v_fma_f32 v43, -v41, v42, 1.0
    v_fma_f32 v42, v43, v42, v42
    v_cvt_pk_bf16_f32 v44, v32, v33
    v_lshlrev_b32 v45, 16, v44
    v_and_b32 v46, 0xffff0000, v44
    v_mul_f32 v45, v45, v42
    v_mul_f32 v46, v46, v42
    v_cvt_pk_bf16_f32 v224, v45, v46
    v_cvt_pk_bf16_f32 v44, v34, v35
    v_lshlrev_b32 v45, 16, v44
    v_and_b32 v46, 0xffff0000, v44
    v_mul_f32 v45, v45, v42
    v_mul_f32 v46, v46, v42
    v_cvt_pk_bf16_f32 v225, v45, v46
    v_cvt_pk_bf16_f32 v44, v36, v37
    v_lshlrev_b32 v45, 16, v44
    v_and_b32 v46, 0xffff0000, v44
    v_mul_f32 v45, v45, v42
    v_mul_f32 v46, v46, v42
    v_cvt_pk_bf16_f32 v226, v45, v46
    v_cvt_pk_bf16_f32 v44, v38, v39
    v_lshlrev_b32 v45, 16, v44
    v_and_b32 v46, 0xffff0000, v44
    v_mul_f32 v45, v45, v42
    v_mul_f32 v46, v46, v42
    v_cvt_pk_bf16_f32 v227, v45, v46
    v_cvt_pk_bf16_f32 v57, v56, v56
    v_lshlrev_b32 v57, 16, v57
    v_add_f32 v57, 0x358637bd, v57
    v_cvt_pk_bf16_f32 v57, v57, v57
    v_lshlrev_b32 v57, 16, v57
    v_rcp_f32 v58, v57
    s_nop 0
    v_fma_f32 v59, -v57, v58, 1.0
    v_fma_f32 v58, v59, v58, v58
    v_cvt_pk_bf16_f32 v60, v48, v49
    v_lshlrev_b32 v61, 16, v60
    v_and_b32 v62, 0xffff0000, v60
    v_mul_f32 v61, v61, v58
    v_mul_f32 v62, v62, v58
    v_cvt_pk_bf16_f32 v228, v61, v62
    v_cvt_pk_bf16_f32 v60, v50, v51
    v_lshlrev_b32 v61, 16, v60
    v_and_b32 v62, 0xffff0000, v60
    v_mul_f32 v61, v61, v58
    v_mul_f32 v62, v62, v58
    v_cvt_pk_bf16_f32 v229, v61, v62
    v_cvt_pk_bf16_f32 v60, v52, v53
    v_lshlrev_b32 v61, 16, v60
    v_and_b32 v62, 0xffff0000, v60
    v_mul_f32 v61, v61, v58
    v_mul_f32 v62, v62, v58
    v_cvt_pk_bf16_f32 v230, v61, v62
    v_cvt_pk_bf16_f32 v60, v54, v55
    v_lshlrev_b32 v61, 16, v60
    v_and_b32 v62, 0xffff0000, v60
    v_mul_f32 v61, v61, v58
    v_mul_f32 v62, v62, v58
    v_cvt_pk_bf16_f32 v231, v61, v62
    v_mfma_f32_32x32x16_bf16 v[128:143], v[16:19], v[224:227], v[128:143]
    v_mfma_f32_32x32x16_bf16 v[144:159], v[20:23], v[224:227], v[144:159]
    v_mfma_f32_32x32x16_bf16 v[160:175], v[16:19], v[228:231], v[160:175]
    v_mfma_f32_32x32x16_bf16 v[176:191], v[20:23], v[228:231], v[176:191]
    s_waitcnt vmcnt(4)
    ds_read_b64_tr_b16 v[16:17], v4 offset:8192
    ds_read_b64_tr_b16 v[18:19], v4 offset:9216
    ds_read_b64_tr_b16 v[20:21], v5 offset:8192
    ds_read_b64_tr_b16 v[22:23], v5 offset:9216
    s_waitcnt lgkmcnt(4)
    v_mfma_f32_32x32x16_bf16 v[32:47], v[212:215], a[48:51], 0
    v_mfma_f32_32x32x16_bf16 v[48:63], v[212:215], a[52:55], 0
    s_nop 10
    v_cvt_pk_bf16_f32 v41, v40, v40
    v_lshlrev_b32 v41, 16, v41
    v_add_f32 v41, 0x358637bd, v41
    v_cvt_pk_bf16_f32 v41, v41, v41
    v_lshlrev_b32 v41, 16, v41
    v_rcp_f32 v42, v41
    s_nop 0
    v_fma_f32 v43, -v41, v42, 1.0
    v_fma_f32 v42, v43, v42, v42
    v_cvt_pk_bf16_f32 v44, v32, v33
    v_lshlrev_b32 v45, 16, v44
    v_and_b32 v46, 0xffff0000, v44
    v_mul_f32 v45, v45, v42
    v_mul_f32 v46, v46, v42
    v_cvt_pk_bf16_f32 v224, v45, v46
    v_cvt_pk_bf16_f32 v44, v34, v35
    v_lshlrev_b32 v45, 16, v44
    v_and_b32 v46, 0xffff0000, v44
    v_mul_f32 v45, v45, v42
    v_mul_f32 v46, v46, v42
    v_cvt_pk_bf16_f32 v225, v45, v46
    v_cvt_pk_bf16_f32 v44, v36, v37
    v_lshlrev_b32 v45, 16, v44
    v_and_b32 v46, 0xffff0000, v44
    v_mul_f32 v45, v45, v42
    v_mul_f32 v46, v46, v42
    v_cvt_pk_bf16_f32 v226, v45, v46
    v_cvt_pk_bf16_f32 v44, v38, v39
    v_lshlrev_b32 v45, 16, v44
    v_and_b32 v46, 0xffff0000, v44
    v_mul_f32 v45, v45, v42
    v_mul_f32 v46, v46, v42
    v_cvt_pk_bf16_f32 v227, v45, v46
    v_cvt_pk_bf16_f32 v57, v56, v56
    v_lshlrev_b32 v57, 16, v57
    v_add_f32 v57, 0x358637bd, v57
    v_cvt_pk_bf16_f32 v57, v57, v57
    v_lshlrev_b32 v57, 16, v57
    v_rcp_f32 v58, v57
    s_nop 0
    v_fma_f32 v59, -v57, v58, 1.0
    v_fma_f32 v58, v59, v58, v58
    v_cvt_pk_bf16_f32 v60, v48, v49
    v_lshlrev_b32 v61, 16, v60
    v_and_b32 v62, 0xffff0000, v60
    v_mul_f32 v61, v61, v58
    v_mul_f32 v62, v62, v58
    v_cvt_pk_bf16_f32 v228, v61, v62
    v_cvt_pk_bf16_f32 v60, v50, v51
    v_lshlrev_b32 v61, 16, v60
    v_and_b32 v62, 0xffff0000, v60
    v_mul_f32 v61, v61, v58
    v_mul_f32 v62, v62, v58
    v_cvt_pk_bf16_f32 v229, v61, v62
    v_cvt_pk_bf16_f32 v60, v52, v53
    v_lshlrev_b32 v61, 16, v60
    v_and_b32 v62, 0xffff0000, v60
    v_mul_f32 v61, v61, v58
    v_mul_f32 v62, v62, v58
    v_cvt_pk_bf16_f32 v230, v61, v62
    v_cvt_pk_bf16_f32 v60, v54, v55
    v_lshlrev_b32 v61, 16, v60
    v_and_b32 v62, 0xffff0000, v60
    v_mul_f32 v61, v61, v58
    v_mul_f32 v62, v62, v58
    v_cvt_pk_bf16_f32 v231, v61, v62
    v_mfma_f32_32x32x16_bf16 v[128:143], v[24:27], v[224:227], v[128:143]
    v_mfma_f32_32x32x16_bf16 v[144:159], v[28:31], v[224:227], v[144:159]
    v_mfma_f32_32x32x16_bf16 v[160:175], v[24:27], v[228:231], v[160:175]
    v_mfma_f32_32x32x16_bf16 v[176:191], v[28:31], v[228:231], v[176:191]
    s_waitcnt vmcnt(0)
    ds_read_b64_tr_b16 v[24:25], v4 offset:10240
    ds_read_b64_tr_b16 v[26:27], v4 offset:11264
    ds_read_b64_tr_b16 v[28:29], v5 offset:10240
    ds_read_b64_tr_b16 v[30:31], v5 offset:11264
    s_waitcnt lgkmcnt(4)
    v_mfma_f32_32x32x16_bf16 v[32:47], v[216:219], a[56:59], 0
    v_mfma_f32_32x32x16_bf16 v[48:63], v[216:219], a[60:63], 0
    s_nop 10
    v_cvt_pk_bf16_f32 v41, v40, v40
    v_lshlrev_b32 v41, 16, v41
    v_add_f32 v41, 0x358637bd, v41
    v_cvt_pk_bf16_f32 v41, v41, v41
    v_lshlrev_b32 v41, 16, v41
    v_rcp_f32 v42, v41
    s_nop 0
    v_fma_f32 v43, -v41, v42, 1.0
    v_fma_f32 v42, v43, v42, v42
    v_cvt_pk_bf16_f32 v44, v32, v33
    v_lshlrev_b32 v45, 16, v44
    v_and_b32 v46, 0xffff0000, v44
    v_mul_f32 v45, v45, v42
    v_mul_f32 v46, v46, v42
    v_cvt_pk_bf16_f32 v224, v45, v46
    v_cvt_pk_bf16_f32 v44, v34, v35
    v_lshlrev_b32 v45, 16, v44
    v_and_b32 v46, 0xffff0000, v44
    v_mul_f32 v45, v45, v42
    v_mul_f32 v46, v46, v42
    v_cvt_pk_bf16_f32 v225, v45, v46
    v_cvt_pk_bf16_f32 v44, v36, v37
    v_lshlrev_b32 v45, 16, v44
    v_and_b32 v46, 0xffff0000, v44
    v_mul_f32 v45, v45, v42
    v_mul_f32 v46, v46, v42
    v_cvt_pk_bf16_f32 v226, v45, v46
    v_cvt_pk_bf16_f32 v44, v38, v39
    v_lshlrev_b32 v45, 16, v44
    v_and_b32 v46, 0xffff0000, v44
    v_mul_f32 v45, v45, v42
    v_mul_f32 v46, v46, v42
    v_cvt_pk_bf16_f32 v227, v45, v46
    v_cvt_pk_bf16_f32 v57, v56, v56
    v_lshlrev_b32 v57, 16, v57
    v_add_f32 v57, 0x358637bd, v57
    v_cvt_pk_bf16_f32 v57, v57, v57
    v_lshlrev_b32 v57, 16, v57
    v_rcp_f32 v58, v57
    s_nop 0
    v_fma_f32 v59, -v57, v58, 1.0
    v_fma_f32 v58, v59, v58, v58
    v_cvt_pk_bf16_f32 v60, v48, v49
    v_lshlrev_b32 v61, 16, v60
    v_and_b32 v62, 0xffff0000, v60
    v_mul_f32 v61, v61, v58
    v_mul_f32 v62, v62, v58
    v_cvt_pk_bf16_f32 v228, v61, v62
    v_cvt_pk_bf16_f32 v60, v50, v51
    v_lshlrev_b32 v61, 16, v60
    v_and_b32 v62, 0xffff0000, v60
    v_mul_f32 v61, v61, v58
    v_mul_f32 v62, v62, v58
    v_cvt_pk_bf16_f32 v229, v61, v62
    v_cvt_pk_bf16_f32 v60, v52, v53
    v_lshlrev_b32 v61, 16, v60
    v_and_b32 v62, 0xffff0000, v60
    v_mul_f32 v61, v61, v58
    v_mul_f32 v62, v62, v58
    v_cvt_pk_bf16_f32 v230, v61, v62
    v_cvt_pk_bf16_f32 v60, v54, v55
    v_lshlrev_b32 v61, 16, v60
    v_and_b32 v62, 0xffff0000, v60
    v_mul_f32 v61, v61, v58
    v_mul_f32 v62, v62, v58
    v_cvt_pk_bf16_f32 v231, v61, v62
    v_mfma_f32_32x32x16_bf16 v[128:143], v[16:19], v[224:227], v[128:143]
    v_mfma_f32_32x32x16_bf16 v[144:159], v[20:23], v[224:227], v[144:159]
    v_mfma_f32_32x32x16_bf16 v[160:175], v[16:19], v[228:231], v[160:175]
    v_mfma_f32_32x32x16_bf16 v[176:191], v[20:23], v[228:231], v[176:191]
    s_waitcnt lgkmcnt(0)
    v_mfma_f32_32x32x16_bf16 v[32:47], v[220:223], a[64:67], 0
    v_mfma_f32_32x32x16_bf16 v[48:63], v[220:223], a[68:71], 0
    s_nop 10
    v_cvt_pk_bf16_f32 v41, v40, v40
    v_lshlrev_b32 v41, 16, v41
    v_add_f32 v41, 0x358637bd, v41
    v_cvt_pk_bf16_f32 v41, v41, v41
    v_lshlrev_b32 v41, 16, v41
    v_rcp_f32 v42, v41
    s_nop 0
    v_fma_f32 v43, -v41, v42, 1.0
    v_fma_f32 v42, v43, v42, v42
    v_cvt_pk_bf16_f32 v44, v32, v33
    v_lshlrev_b32 v45, 16, v44
    v_and_b32 v46, 0xffff0000, v44
    v_mul_f32 v45, v45, v42
    v_mul_f32 v46, v46, v42
    v_cvt_pk_bf16_f32 v224, v45, v46
    v_cvt_pk_bf16_f32 v44, v34, v35
    v_lshlrev_b32 v45, 16, v44
    v_and_b32 v46, 0xffff0000, v44
    v_mul_f32 v45, v45, v42
    v_mul_f32 v46, v46, v42
    v_cvt_pk_bf16_f32 v225, v45, v46
    v_cvt_pk_bf16_f32 v44, v36, v37
    v_lshlrev_b32 v45, 16, v44
    v_and_b32 v46, 0xffff0000, v44
    v_mul_f32 v45, v45, v42
    v_mul_f32 v46, v46, v42
    v_cvt_pk_bf16_f32 v226, v45, v46
    v_cvt_pk_bf16_f32 v44, v38, v39
    v_lshlrev_b32 v45, 16, v44
    v_and_b32 v46, 0xffff0000, v44
    v_mul_f32 v45, v45, v42
    v_mul_f32 v46, v46, v42
    v_cvt_pk_bf16_f32 v227, v45, v46
    v_cvt_pk_bf16_f32 v57, v56, v56
    v_lshlrev_b32 v57, 16, v57
    v_add_f32 v57, 0x358637bd, v57
    v_cvt_pk_bf16_f32 v57, v57, v57
    v_lshlrev_b32 v57, 16, v57
    v_rcp_f32 v58, v57
    s_nop 0
    v_fma_f32 v59, -v57, v58, 1.0
    v_fma_f32 v58, v59, v58, v58
    v_cvt_pk_bf16_f32 v60, v48, v49
    v_lshlrev_b32 v61, 16, v60
    v_and_b32 v62, 0xffff0000, v60
    v_mul_f32 v61, v61, v58
    v_mul_f32 v62, v62, v58
    v_cvt_pk_bf16_f32 v228, v61, v62
    v_cvt_pk_bf16_f32 v60, v50, v51
    v_lshlrev_b32 v61, 16, v60
    v_and_b32 v62, 0xffff0000, v60
    v_mul_f32 v61, v61, v58
    v_mul_f32 v62, v62, v58
    v_cvt_pk_bf16_f32 v229, v61, v62
    v_cvt_pk_bf16_f32 v60, v52, v53
    v_lshlrev_b32 v61, 16, v60
    v_and_b32 v62, 0xffff0000, v60
    v_mul_f32 v61, v61, v58
    v_mul_f32 v62, v62, v58
    v_cvt_pk_bf16_f32 v230, v61, v62
    v_cvt_pk_bf16_f32 v60, v54, v55
    v_lshlrev_b32 v61, 16, v60
    v_and_b32 v62, 0xffff0000, v60
    v_mul_f32 v61, v61, v58
    v_mul_f32 v62, v62, v58
    v_cvt_pk_bf16_f32 v231, v61, v62
    v_mfma_f32_32x32x16_bf16 v[128:143], v[24:27], v[224:227], v[128:143]
    v_mfma_f32_32x32x16_bf16 v[144:159], v[28:31], v[224:227], v[144:159]
    v_mfma_f32_32x32x16_bf16 v[160:175], v[24:27], v[228:231], v[160:175]
    v_mfma_f32_32x32x16_bf16 v[176:191], v[28:31], v[228:231], v[176:191]
    s_nop 7
    s_nop 4
    s_barrier
    v_mov_b32 v20, v6
    s_cmp_lg_u32 s18, 0
    s_cbranch_scc1 L_k2_w0_skip
    v_add_u32 v21, 24576, v20
    ds_write_b128 v21, v[80:83] offset:0
    ds_write_b128 v21, v[84:87] offset:1024
    ds_write_b128 v21, v[88:91] offset:2048
    ds_write_b128 v21, v[92:95] offset:3072
    ds_write_b128 v21, v[144:147] offset:4096
    ds_write_b128 v21, v[148:151] offset:5120
    ds_write_b128 v21, v[152:155] offset:6144
    ds_write_b128 v21, v[156:159] offset:7168
    v_add_u32 v21, 49152, v20
    ds_write_b128 v21, v[96:99] offset:0
    ds_write_b128 v21, v[100:103] offset:1024
    ds_write_b128 v21, v[104:107] offset:2048
    ds_write_b128 v21, v[108:111] offset:3072
    ds_write_b128 v21, v[160:163] offset:4096
    ds_write_b128 v21, v[164:167] offset:5120
    ds_write_b128 v21, v[168:171] offset:6144
    ds_write_b128 v21, v[172:175] offset:7168
    v_add_u32 v21, 73728, v20
    ds_write_b128 v21, v[112:115] offset:0
    ds_write_b128 v21, v[116:119] offset:1024
    ds_write_b128 v21, v[120:123] offset:2048
    ds_write_b128 v21, v[124:127] offset:3072
    ds_write_b128 v21, v[176:179] offset:4096
    ds_write_b128 v21, v[180:183] offset:5120
    ds_write_b128 v21, v[184:187] offset:6144
    ds_write_b128 v21, v[188:191] offset:7168
L_k2_w0_skip:
    s_cmp_lg_u32 s18, 1
    s_cbranch_scc1 L_k2_w1_skip
    v_add_u32 v21, 0, v20
    ds_write_b128 v21, v[64:67] offset:0
    ds_write_b128 v21, v[68:71] offset:1024
    ds_write_b128 v21, v[72:75] offset:2048
    ds_write_b128 v21, v[76:79] offset:3072
    ds_write_b128 v21, v[128:131] offset:4096
    ds_write_b128 v21, v[132:135] offset:5120
    ds_write_b128 v21, v[136:139] offset:6144
    ds_write_b128 v21, v[140:143] offset:7168
    v_add_u32 v21, 49152, v20
    ds_write_b128 v21, v[96:99] offset:8192
    ds_write_b128 v21, v[100:103] offset:9216
    ds_write_b128 v21, v[104:107] offset:10240
    ds_write_b128 v21, v[108:111] offset:11264
    ds_write_b128 v21, v[160:163] offset:12288
    ds_write_b128 v21, v[164:167] offset:13312
    ds_write_b128 v21, v[168:171] offset:14336
    ds_write_b128 v21, v[172:175] offset:15360
    v_add_u32 v21, 73728, v20
    ds_write_b128 v21, v[112:115] offset:8192
    ds_write_b128 v21, v[116:119] offset:9216
    ds_write_b128 v21, v[120:123] offset:10240
    ds_write_b128 v21, v[124:127] offset:11264
    ds_write_b128 v21, v[176:179] offset:12288
    ds_write_b128 v21, v[180:183] offset:13312
    ds_write_b128 v21, v[184:187] offset:14336
    ds_write_b128 v21, v[188:191] offset:15360
L_k2_w1_skip:
    s_cmp_lg_u32 s18, 2
    s_cbranch_scc1 L_k2_w2_skip
    v_add_u32 v21, 0, v20
    ds_write_b128 v21, v[64:67] offset:8192
    ds_write_b128 v21, v[68:71] offset:9216
    ds_write_b128 v21, v[72:75] offset:10240
    ds_write_b128 v21, v[76:79] offset:11264
    ds_write_b128 v21, v[128:131] offset:12288
    ds_write_b128 v21, v[132:135] offset:13312
    ds_write_b128 v21, v[136:139] offset:14336
    ds_write_b128 v21, v[140:143] offset:15360
    v_add_u32 v21, 24576, v20
    ds_write_b128 v21, v[80:83] offset:8192
    ds_write_b128 v21, v[84:87] offset:9216
    ds_write_b128 v21, v[88:91] offset:10240
    ds_write_b128 v21, v[92:95] offset:11264
    ds_write_b128 v21, v[144:147] offset:12288
    ds_write_b128 v21, v[148:151] offset:13312
    ds_write_b128 v21, v[152:155] offset:14336
    ds_write_b128 v21, v[156:159] offset:15360
    v_add_u32 v21, 73728, v20
    ds_write_b128 v21, v[112:115] offset:16384
    ds_write_b128 v21, v[116:119] offset:17408
    ds_write_b128 v21, v[120:123] offset:18432
    ds_write_b128 v21, v[124:127] offset:19456
    ds_write_b128 v21, v[176:179] offset:20480
    ds_write_b128 v21, v[180:183] offset:21504
    ds_write_b128 v21, v[184:187] offset:22528
    ds_write_b128 v21, v[188:191] offset:23552
L_k2_w2_skip:
    s_cmp_lg_u32 s18, 3
    s_cbranch_scc1 L_k2_w3_skip
    v_add_u32 v21, 0, v20
    ds_write_b128 v21, v[64:67] offset:16384
    ds_write_b128 v21, v[68:71] offset:17408
    ds_write_b128 v21, v[72:75] offset:18432
    ds_write_b128 v21, v[76:79] offset:19456
    ds_write_b128 v21, v[128:131] offset:20480
    ds_write_b128 v21, v[132:135] offset:21504
    ds_write_b128 v21, v[136:139] offset:22528
    ds_write_b128 v21, v[140:143] offset:23552
    v_add_u32 v21, 24576, v20
    ds_write_b128 v21, v[80:83] offset:16384
    ds_write_b128 v21, v[84:87] offset:17408
    ds_write_b128 v21, v[88:91] offset:18432
    ds_write_b128 v21, v[92:95] offset:19456
    ds_write_b128 v21, v[144:147] offset:20480
    ds_write_b128 v21, v[148:151] offset:21504
    ds_write_b128 v21, v[152:155] offset:22528
    ds_write_b128 v21, v[156:159] offset:23552
    v_add_u32 v21, 49152, v20
    ds_write_b128 v21, v[96:99] offset:16384
    ds_write_b128 v21, v[100:103] offset:17408
    ds_write_b128 v21, v[104:107] offset:18432
    ds_write_b128 v21, v[108:111] offset:19456
    ds_write_b128 v21, v[160:163] offset:20480
    ds_write_b128 v21, v[164:167] offset:21504
    ds_write_b128 v21, v[168:171] offset:22528
    ds_write_b128 v21, v[172:175] offset:23552
L_k2_w3_skip:
    s_waitcnt lgkmcnt(0)
    s_barrier
    s_cmp_lg_u32 s18, 0
    s_cbranch_scc1 L_k2_r0_skip
    v_mov_b32 v32, v64
    v_mov_b32 v33, v65
    v_mov_b32 v34, v66
    v_mov_b32 v35, v67
    v_mov_b32 v36, v68
    v_mov_b32 v37, v69
    v_mov_b32 v38, v70
    v_mov_b32 v39, v71
    v_mov_b32 v40, v72
    v_mov_b32 v41, v73
    v_mov_b32 v42, v74
    v_mov_b32 v43, v75
    v_mov_b32 v44, v76
    v_mov_b32 v45, v77
    v_mov_b32 v46, v78
    v_mov_b32 v47, v79
    v_mov_b32 v48, v128
    v_mov_b32 v49, v129
    v_mov_b32 v50, v130
    v_mov_b32 v51, v131
    v_mov_b32 v52, v132
    v_mov_b32 v53, v133
    v_mov_b32 v54, v134
    v_mov_b32 v55, v135
    v_mov_b32 v56, v136
    v_mov_b32 v57, v137
    v_mov_b32 v58, v138
    v_mov_b32 v59, v139
    v_mov_b32 v60, v140
    v_mov_b32 v61, v141
    v_mov_b32 v62, v142
    v_mov_b32 v63, v143
    v_add_u32 v21, 0, v20
    ds_read_b128 v[160:163], v21 offset:0
    ds_read_b128 v[164:167], v21 offset:1024
    ds_read_b128 v[168:171], v21 offset:2048
    ds_read_b128 v[172:175], v21 offset:3072
    ds_read_b128 v[176:179], v21 offset:8192
    ds_read_b128 v[180:183], v21 offset:9216
    ds_read_b128 v[184:187], v21 offset:10240
    ds_read_b128 v[188:191], v21 offset:11264
    ds_read_b128 v[192:195], v21 offset:16384
    ds_read_b128 v[196:199], v21 offset:17408
    ds_read_b128 v[200:203], v21 offset:18432
    ds_read_b128 v[204:207], v21 offset:19456
    ds_read_b128 v[208:211], v21 offset:4096
    ds_read_b128 v[212:215], v21 offset:5120
    ds_read_b128 v[216:219], v21 offset:6144
    ds_read_b128 v[220:223], v21 offset:7168
    ds_read_b128 v[224:227], v21 offset:12288
    ds_read_b128 v[228:231], v21 offset:13312
    ds_read_b128 v[232:235], v21 offset:14336
    ds_read_b128 v[236:239], v21 offset:15360
    ds_read_b128 v[240:243], v21 offset:20480
    ds_read_b128 v[244:247], v21 offset:21504
    ds_read_b128 v[248:251], v21 offset:22528
    ds_read_b128 v[252:255], v21 offset:23552
L_k2_r0_skip:
    s_cmp_lg_u32 s18, 1
    s_cbranch_scc1 L_k2_r1_skip
    v_mov_b32 v32, v80
    v_mov_b32 v33, v81
    v_mov_b32 v34, v82
    v_mov_b32 v35, v83
    v_mov_b32 v36, v84
    v_mov_b32 v37, v85
    v_mov_b32 v38, v86
    v_mov_b32 v39, v87
    v_mov_b32 v40, v88
    v_mov_b32 v41, v89
    v_mov_b32 v42, v90
    v_mov_b32 v43, v91
    v_mov_b32 v44, v92
    v_mov_b32 v45, v93
    v_mov_b32 v46, v94
    v_mov_b32 v47, v95
    v_mov_b32 v48, v144
    v_mov_b32 v49, v145
    v_mov_b32 v50, v146
    v_mov_b32 v51, v147
    v_mov_b32 v52, v148
    v_mov_b32 v53, v149
    v_mov_b32 v54, v150
    v_mov_b32 v55, v151
    v_mov_b32 v56, v152
    v_mov_b32 v57, v153
    v_mov_b32 v58, v154
    v_mov_b32 v59, v155
    v_mov_b32 v60, v156
    v_mov_b32 v61, v157
    v_mov_b32 v62, v158
    v_mov_b32 v63, v159
    v_add_u32 v21, 24576, v20
    ds_read_b128 v[160:163], v21 offset:0
    ds_read_b128 v[164:167], v21 offset:1024
    ds_read_b128 v[168:171], v21 offset:2048
    ds_read_b128 v[172:175], v21 offset:3072
    ds_read_b128 v[176:179], v21 offset:8192
    ds_read_b128 v[180:183], v21 offset:9216
    ds_read_b128 v[184:187], v21 offset:10240
    ds_read_b128 v[188:191], v21 offset:11264
    ds_read_b128 v[192:195], v21 offset:16384
    ds_read_b128 v[196:199], v21 offset:17408
    ds_read_b128 v[200:203], v21 offset:18432
    ds_read_b128 v[204:207], v21 offset:19456
    ds_read_b128 v[208:211], v21 offset:4096
    ds_read_b128 v[212:215], v21 offset:5120
    ds_read_b128 v[216:219], v21 offset:6144
    ds_read_b128 v[220:223], v21 offset:7168
    ds_read_b128 v[224:227], v21 offset:12288
    ds_read_b128 v[228:231], v21 offset:13312
    ds_read_b128 v[232:235], v21 offset:14336
    ds_read_b128 v[236:239], v21 offset:15360
    ds_read_b128 v[240:243], v21 offset:20480
    ds_read_b128 v[244:247], v21 offset:21504
    ds_read_b128 v[248:251], v21 offset:22528
    ds_read_b128 v[252:255], v21 offset:23552
L_k2_r1_skip:
    s_cmp_lg_u32 s18, 2
    s_cbranch_scc1 L_k2_r2_skip
    v_mov_b32 v32, v96
    v_mov_b32 v33, v97
    v_mov_b32 v34, v98
    v_mov_b32 v35, v99
    v_mov_b32 v36, v100
    v_mov_b32 v37, v101
    v_mov_b32 v38, v102
    v_mov_b32 v39, v103
    v_mov_b32 v40, v104
    v_mov_b32 v41, v105
    v_mov_b32 v42, v106
    v_mov_b32 v43, v107
    v_mov_b32 v44, v108
    v_mov_b32 v45, v109
    v_mov_b32 v46, v110
    v_mov_b32 v47, v111
    v_mov_b32 v48, v160
    v_mov_b32 v49, v161
    v_mov_b32 v50, v162
    v_mov_b32 v51, v163
    v_mov_b32 v52, v164
    v_mov_b32 v53, v165
    v_mov_b32 v54, v166
    v_mov_b32 v55, v167
    v_mov_b32 v56, v168
    v_mov_b32 v57, v169
    v_mov_b32 v58, v170
    v_mov_b32 v59, v171
    v_mov_b32 v60, v172
    v_mov_b32 v61, v173
    v_mov_b32 v62, v174
    v_mov_b32 v63, v175
    v_add_u32 v21, 49152, v20
    ds_read_b128 v[160:163], v21 offset:0
    ds_read_b128 v[164:167], v21 offset:1024
    ds_read_b128 v[168:171], v21 offset:2048
    ds_read_b128 v[172:175], v21 offset:3072
    ds_read_b128 v[176:179], v21 offset:8192
    ds_read_b128 v[180:183], v21 offset:9216
    ds_read_b128 v[184:187], v21 offset:10240
    ds_read_b128 v[188:191], v21 offset:11264
    ds_read_b128 v[192:195], v21 offset:16384
    ds_read_b128 v[196:199], v21 offset:17408
    ds_read_b128 v[200:203], v21 offset:18432
    ds_read_b128 v[204:207], v21 offset:19456
    ds_read_b128 v[208:211], v21 offset:4096
    ds_read_b128 v[212:215], v21 offset:5120
    ds_read_b128 v[216:219], v21 offset:6144
    ds_read_b128 v[220:223], v21 offset:7168
    ds_read_b128 v[224:227], v21 offset:12288
    ds_read_b128 v[228:231], v21 offset:13312
    ds_read_b128 v[232:235], v21 offset:14336
    ds_read_b128 v[236:239], v21 offset:15360
    ds_read_b128 v[240:243], v21 offset:20480
    ds_read_b128 v[244:247], v21 offset:21504
    ds_read_b128 v[248:251], v21 offset:22528
    ds_read_b128 v[252:255], v21 offset:23552
L_k2_r2_skip:
    s_cmp_lg_u32 s18, 3
    s_cbranch_scc1 L_k2_r3_skip
    v_mov_b32 v32, v112
    v_mov_b32 v33, v113
    v_mov_b32 v34, v114
    v_mov_b32 v35, v115
    v_mov_b32 v36, v116
    v_mov_b32 v37, v117
    v_mov_b32 v38, v118
    v_mov_b32 v39, v119
    v_mov_b32 v40, v120
    v_mov_b32 v41, v121
    v_mov_b32 v42, v122
    v_mov_b32 v43, v123
    v_mov_b32 v44, v124
    v_mov_b32 v45, v125
    v_mov_b32 v46, v126
    v_mov_b32 v47, v127
    v_mov_b32 v48, v176
    v_mov_b32 v49, v177
    v_mov_b32 v50, v178
    v_mov_b32 v51, v179
    v_mov_b32 v52, v180
    v_mov_b32 v53, v181
    v_mov_b32 v54, v182
    v_mov_b32 v55, v183
    v_mov_b32 v56, v184
    v_mov_b32 v57, v185
    v_mov_b32 v58, v186
    v_mov_b32 v59, v187
    v_mov_b32 v60, v188
    v_mov_b32 v61, v189
    v_mov_b32 v62, v190
    v_mov_b32 v63, v191
    v_add_u32 v21, 73728, v20
    ds_read_b128 v[160:163], v21 offset:0
    ds_read_b128 v[164:167], v21 offset:1024
    ds_read_b128 v[168:171], v21 offset:2048
    ds_read_b128 v[172:175], v21 offset:3072
    ds_read_b128 v[176:179], v21 offset:8192
    ds_read_b128 v[180:183], v21 offset:9216
    ds_read_b128 v[184:187], v21 offset:10240
    ds_read_b128 v[188:191], v21 offset:11264
    ds_read_b128 v[192:195], v21 offset:16384
    ds_read_b128 v[196:199], v21 offset:17408
    ds_read_b128 v[200:203], v21 offset:18432
    ds_read_b128 v[204:207], v21 offset:19456
    ds_read_b128 v[208:211], v21 offset:4096
    ds_read_b128 v[212:215], v21 offset:5120
    ds_read_b128 v[216:219], v21 offset:6144
    ds_read_b128 v[220:223], v21 offset:7168
    ds_read_b128 v[224:227], v21 offset:12288
    ds_read_b128 v[228:231], v21 offset:13312
    ds_read_b128 v[232:235], v21 offset:14336
    ds_read_b128 v[236:239], v21 offset:15360
    ds_read_b128 v[240:243], v21 offset:20480
    ds_read_b128 v[244:247], v21 offset:21504
    ds_read_b128 v[248:251], v21 offset:22528
    ds_read_b128 v[252:255], v21 offset:23552
L_k2_r3_skip:
    s_waitcnt lgkmcnt(0)
    v_pk_add_f32 v[32:33], v[32:33], v[160:161]
    v_pk_add_f32 v[34:35], v[34:35], v[162:163]
    v_pk_add_f32 v[36:37], v[36:37], v[164:165]
    v_pk_add_f32 v[38:39], v[38:39], v[166:167]
    v_pk_add_f32 v[40:41], v[40:41], v[168:169]
    v_pk_add_f32 v[42:43], v[42:43], v[170:171]
    v_pk_add_f32 v[44:45], v[44:45], v[172:173]
    v_pk_add_f32 v[46:47], v[46:47], v[174:175]
    v_pk_add_f32 v[32:33], v[32:33], v[176:177]
    v_pk_add_f32 v[34:35], v[34:35], v[178:179]
    v_pk_add_f32 v[36:37], v[36:37], v[180:181]
    v_pk_add_f32 v[38:39], v[38:39], v[182:183]
    v_pk_add_f32 v[40:41], v[40:41], v[184:185]
    v_pk_add_f32 v[42:43], v[42:43], v[186:187]
    v_pk_add_f32 v[44:45], v[44:45], v[188:189]
    v_pk_add_f32 v[46:47], v[46:47], v[190:191]
    v_pk_add_f32 v[32:33], v[32:33], v[192:193]
    v_pk_add_f32 v[34:35], v[34:35], v[194:195]
    v_pk_add_f32 v[36:37], v[36:37], v[196:197]
    v_pk_add_f32 v[38:39], v[38:39], v[198:199]
    v_pk_add_f32 v[40:41], v[40:41], v[200:201]
    v_pk_add_f32 v[42:43], v[42:43], v[202:203]
    v_pk_add_f32 v[44:45], v[44:45], v[204:205]
    v_pk_add_f32 v[46:47], v[46:47], v[206:207]
    v_pk_add_f32 v[48:49], v[48:49], v[208:209]
    v_pk_add_f32 v[50:51], v[50:51], v[210:211]
    v_pk_add_f32 v[52:53], v[52:53], v[212:213]
    v_pk_add_f32 v[54:55], v[54:55], v[214:215]
    v_pk_add_f32 v[56:57], v[56:57], v[216:217]
    v_pk_add_f32 v[58:59], v[58:59], v[218:219]
    v_pk_add_f32 v[60:61], v[60:61], v[220:221]
    v_pk_add_f32 v[62:63], v[62:63], v[222:223]
    v_pk_add_f32 v[48:49], v[48:49], v[224:225]
    v_pk_add_f32 v[50:51], v[50:51], v[226:227]
    v_pk_add_f32 v[52:53], v[52:53], v[228:229]
    v_pk_add_f32 v[54:55], v[54:55], v[230:231]
    v_pk_add_f32 v[56:57], v[56:57], v[232:233]
    v_pk_add_f32 v[58:59], v[58:59], v[234:235]
    v_pk_add_f32 v[60:61], v[60:61], v[236:237]
    v_pk_add_f32 v[62:63], v[62:63], v[238:239]
    v_pk_add_f32 v[48:49], v[48:49], v[240:241]
    v_pk_add_f32 v[50:51], v[50:51], v[242:243]
    v_pk_add_f32 v[52:53], v[52:53], v[244:245]
    v_pk_add_f32 v[54:55], v[54:55], v[246:247]
    v_pk_add_f32 v[56:57], v[56:57], v[248:249]
    v_pk_add_f32 v[58:59], v[58:59], v[250:251]
    v_pk_add_f32 v[60:61], v[60:61], v[252:253]
    v_pk_add_f32 v[62:63], v[62:63], v[254:255]
    s_waitcnt vmcnt(0)
    v_cvt_pk_bf16_f32 v20, v32, v33
    v_lshlrev_b32 v22, 16, v20
    v_and_b32 v23, 0xffff0000, v20
    v_pk_mul_f32 v[24:25], v[22:23], s[46:47]
    v_exp_f32 v24, v24
    v_exp_f32 v25, v25
    s_nop 0
    v_pk_add_f32 v[24:25], v[24:25], s[44:45]
    v_rcp_f32 v24, v24
    v_rcp_f32 v25, v25
    s_nop 0
    v_pk_mul_f32 v[24:25], v[24:25], v[22:23]
    v_cvt_pk_bf16_f32 v20, v24, v25
    v_lshlrev_b32 v24, 16, v20
    v_and_b32 v25, 0xffff0000, v20
    v_cvt_pk_bf16_f32 v20, v48, v49
    v_lshlrev_b32 v22, 16, v20
    v_and_b32 v23, 0xffff0000, v20
    v_pk_mul_f32 v[24:25], v[24:25], v[22:23]
    v_cvt_pk_bf16_f32 v20, v24, v25
    v_lshlrev_b32 v24, 16, v20
    v_and_b32 v25, 0xffff0000, v20
    v_lshlrev_b32 v22, 16, v8
    v_and_b32 v23, 0xffff0000, v8
    v_pk_add_f32 v[24:25], v[24:25], v[22:23]
    v_cvt_pk_bf16_f32 v26, v24, v25
    v_cvt_pk_bf16_f32 v20, v34, v35
    v_lshlrev_b32 v22, 16, v20
    v_and_b32 v23, 0xffff0000, v20
    v_pk_mul_f32 v[24:25], v[22:23], s[46:47]
    v_exp_f32 v24, v24
    v_exp_f32 v25, v25
    s_nop 0
    v_pk_add_f32 v[24:25], v[24:25], s[44:45]
    v_rcp_f32 v24, v24
    v_rcp_f32 v25, v25
    s_nop 0
    v_pk_mul_f32 v[24:25], v[24:25], v[22:23]
    v_cvt_pk_bf16_f32 v20, v24, v25
    v_lshlrev_b32 v24, 16, v20
    v_and_b32 v25, 0xffff0000, v20
    v_cvt_pk_bf16_f32 v20, v50, v51
    v_lshlrev_b32 v22, 16, v20
    v_and_b32 v23, 0xffff0000, v20
    v_pk_mul_f32 v[24:25], v[24:25], v[22:23]
    v_cvt_pk_bf16_f32 v20, v24, v25
    v_lshlrev_b32 v24, 16, v20
    v_and_b32 v25, 0xffff0000, v20
    v_lshlrev_b32 v22, 16, v9
    v_and_b32 v23, 0xffff0000, v9
    v_pk_add_f32 v[24:25], v[24:25], v[22:23]
    v_cvt_pk_bf16_f32 v27, v24, v25
    buffer_store_dwordx2 v[26:27], v7, s[36:39], 0 offen offset:0
    v_cvt_pk_bf16_f32 v20, v36, v37
    v_lshlrev_b32 v22, 16, v20
    v_and_b32 v23, 0xffff0000, v20
    v_pk_mul_f32 v[24:25], v[22:23], s[46:47]
    v_exp_f32 v24, v24
    v_exp_f32 v25, v25
    s_nop 0
    v_pk_add_f32 v[24:25], v[24:25], s[44:45]
    v_rcp_f32 v24, v24
    v_rcp_f32 v25, v25
    s_nop 0
    v_pk_mul_f32 v[24:25], v[24:25], v[22:23]
    v_cvt_pk_bf16_f32 v20, v24, v25
    v_lshlrev_b32 v24, 16, v20
    v_and_b32 v25, 0xffff0000, v20
    v_cvt_pk_bf16_f32 v20, v52, v53
    v_lshlrev_b32 v22, 16, v20
    v_and_b32 v23, 0xffff0000, v20
    v_pk_mul_f32 v[24:25], v[24:25], v[22:23]
    v_cvt_pk_bf16_f32 v20, v24, v25
    v_lshlrev_b32 v24, 16, v20
    v_and_b32 v25, 0xffff0000, v20
    v_lshlrev_b32 v22, 16, v10
    v_and_b32 v23, 0xffff0000, v10
    v_pk_add_f32 v[24:25], v[24:25], v[22:23]
    v_cvt_pk_bf16_f32 v26, v24, v25
    v_cvt_pk_bf16_f32 v20, v38, v39
    v_lshlrev_b32 v22, 16, v20
    v_and_b32 v23, 0xffff0000, v20
    v_pk_mul_f32 v[24:25], v[22:23], s[46:47]
    v_exp_f32 v24, v24
    v_exp_f32 v25, v25
    s_nop 0
    v_pk_add_f32 v[24:25], v[24:25], s[44:45]
    v_rcp_f32 v24, v24
    v_rcp_f32 v25, v25
    s_nop 0
    v_pk_mul_f32 v[24:25], v[24:25], v[22:23]
    v_cvt_pk_bf16_f32 v20, v24, v25
    v_lshlrev_b32 v24, 16, v20
    v_and_b32 v25, 0xffff0000, v20
    v_cvt_pk_bf16_f32 v20, v54, v55
    v_lshlrev_b32 v22, 16, v20
    v_and_b32 v23, 0xffff0000, v20
    v_pk_mul_f32 v[24:25], v[24:25], v[22:23]
    v_cvt_pk_bf16_f32 v20, v24, v25
    v_lshlrev_b32 v24, 16, v20
    v_and_b32 v25, 0xffff0000, v20
    v_lshlrev_b32 v22, 16, v11
    v_and_b32 v23, 0xffff0000, v11
    v_pk_add_f32 v[24:25], v[24:25], v[22:23]
    v_cvt_pk_bf16_f32 v27, v24, v25
    buffer_store_dwordx2 v[26:27], v7, s[36:39], 0 offen offset:16
    v_cvt_pk_bf16_f32 v20, v40, v41
    v_lshlrev_b32 v22, 16, v20
    v_and_b32 v23, 0xffff0000, v20
    v_pk_mul_f32 v[24:25], v[22:23], s[46:47]
    v_exp_f32 v24, v24
    v_exp_f32 v25, v25
    s_nop 0
    v_pk_add_f32 v[24:25], v[24:25], s[44:45]
    v_rcp_f32 v24, v24
    v_rcp_f32 v25, v25
    s_nop 0
    v_pk_mul_f32 v[24:25], v[24:25], v[22:23]
    v_cvt_pk_bf16_f32 v20, v24, v25
    v_lshlrev_b32 v24, 16, v20
    v_and_b32 v25, 0xffff0000, v20
    v_cvt_pk_bf16_f32 v20, v56, v57
    v_lshlrev_b32 v22, 16, v20
    v_and_b32 v23, 0xffff0000, v20
    v_pk_mul_f32 v[24:25], v[24:25], v[22:23]
    v_cvt_pk_bf16_f32 v20, v24, v25
    v_lshlrev_b32 v24, 16, v20
    v_and_b32 v25, 0xffff0000, v20
    v_lshlrev_b32 v22, 16, v12
    v_and_b32 v23, 0xffff0000, v12
    v_pk_add_f32 v[24:25], v[24:25], v[22:23]
    v_cvt_pk_bf16_f32 v26, v24, v25
    v_cvt_pk_bf16_f32 v20, v42, v43
    v_lshlrev_b32 v22, 16, v20
    v_and_b32 v23, 0xffff0000, v20
    v_pk_mul_f32 v[24:25], v[22:23], s[46:47]
    v_exp_f32 v24, v24
    v_exp_f32 v25, v25
    s_nop 0
    v_pk_add_f32 v[24:25], v[24:25], s[44:45]
    v_rcp_f32 v24, v24
    v_rcp_f32 v25, v25
    s_nop 0
    v_pk_mul_f32 v[24:25], v[24:25], v[22:23]
    v_cvt_pk_bf16_f32 v20, v24, v25
    v_lshlrev_b32 v24, 16, v20
    v_and_b32 v25, 0xffff0000, v20
    v_cvt_pk_bf16_f32 v20, v58, v59
    v_lshlrev_b32 v22, 16, v20
    v_and_b32 v23, 0xffff0000, v20
    v_pk_mul_f32 v[24:25], v[24:25], v[22:23]
    v_cvt_pk_bf16_f32 v20, v24, v25
    v_lshlrev_b32 v24, 16, v20
    v_and_b32 v25, 0xffff0000, v20
    v_lshlrev_b32 v22, 16, v13
    v_and_b32 v23, 0xffff0000, v13
    v_pk_add_f32 v[24:25], v[24:25], v[22:23]
    v_cvt_pk_bf16_f32 v27, v24, v25
    buffer_store_dwordx2 v[26:27], v7, s[36:39], 0 offen offset:32
    v_cvt_pk_bf16_f32 v20, v44, v45
    v_lshlrev_b32 v22, 16, v20
    v_and_b32 v23, 0xffff0000, v20
    v_pk_mul_f32 v[24:25], v[22:23], s[46:47]
    v_exp_f32 v24, v24
    v_exp_f32 v25, v25
    s_nop 0
    v_pk_add_f32 v[24:25], v[24:25], s[44:45]
    v_rcp_f32 v24, v24
    v_rcp_f32 v25, v25
    s_nop 0
    v_pk_mul_f32 v[24:25], v[24:25], v[22:23]
    v_cvt_pk_bf16_f32 v20, v24, v25
    v_lshlrev_b32 v24, 16, v20
    v_and_b32 v25, 0xffff0000, v20
    v_cvt_pk_bf16_f32 v20, v60, v61
    v_lshlrev_b32 v22, 16, v20
    v_and_b32 v23, 0xffff0000, v20
    v_pk_mul_f32 v[24:25], v[24:25], v[22:23]
    v_cvt_pk_bf16_f32 v20, v24, v25
    v_lshlrev_b32 v24, 16, v20
    v_and_b32 v25, 0xffff0000, v20
    v_lshlrev_b32 v22, 16, v14
    v_and_b32 v23, 0xffff0000, v14
    v_pk_add_f32 v[24:25], v[24:25], v[22:23]
    v_cvt_pk_bf16_f32 v26, v24, v25
    v_cvt_pk_bf16_f32 v20, v46, v47
    v_lshlrev_b32 v22, 16, v20
    v_and_b32 v23, 0xffff0000, v20
    v_pk_mul_f32 v[24:25], v[22:23], s[46:47]
    v_exp_f32 v24, v24
    v_exp_f32 v25, v25
    s_nop 0
    v_pk_add_f32 v[24:25], v[24:25], s[44:45]
    v_rcp_f32 v24, v24
    v_rcp_f32 v25, v25
    s_nop 0
    v_pk_mul_f32 v[24:25], v[24:25], v[22:23]
    v_cvt_pk_bf16_f32 v20, v24, v25
    v_lshlrev_b32 v24, 16, v20
    v_and_b32 v25, 0xffff0000, v20
    v_cvt_pk_bf16_f32 v20, v62, v63
    v_lshlrev_b32 v22, 16, v20
    v_and_b32 v23, 0xffff0000, v20
    v_pk_mul_f32 v[24:25], v[24:25], v[22:23]
    v_cvt_pk_bf16_f32 v20, v24, v25
    v_lshlrev_b32 v24, 16, v20
    v_and_b32 v25, 0xffff0000, v20
    v_lshlrev_b32 v22, 16, v15
    v_and_b32 v23, 0xffff0000, v15
    v_pk_add_f32 v[24:25], v[24:25], v[22:23]
    v_cvt_pk_bf16_f32 v27, v24, v25
    buffer_store_dwordx2 v[26:27], v7, s[36:39], 0 offen offset:48
L_k2_end:
    s_endpgm
.section .rodata,"a"
.p2align 6
.amdhsa_kernel ln_kernel
  .amdhsa_next_free_vgpr 40
  .amdhsa_next_free_sgpr 24
  .amdhsa_accum_offset 40
  .amdhsa_group_segment_fixed_size 0
  .amdhsa_kernarg_size 80
  .amdhsa_user_sgpr_count 2
  .amdhsa_user_sgpr_kernarg_segment_ptr 1
  .amdhsa_system_sgpr_workgroup_id_x 1
.end_amdhsa_kernel
.p2align 6
.amdhsa_kernel k1_kernel
  .amdhsa_next_free_vgpr 256
  .amdhsa_next_free_sgpr 100
  .amdhsa_accum_offset 128
  .amdhsa_group_segment_fixed_size 0
  .amdhsa_kernarg_size 80
  .amdhsa_user_sgpr_count 2
  .amdhsa_user_sgpr_kernarg_segment_ptr 1
  .amdhsa_system_sgpr_workgroup_id_x 1
.end_amdhsa_kernel
.p2align 6
.amdhsa_kernel k2_kernel
  .amdhsa_next_free_vgpr 328
  .amdhsa_next_free_sgpr 100
  .amdhsa_accum_offset 256
  .amdhsa_group_segment_fixed_size 0
  .amdhsa_kernarg_size 80
  .amdhsa_user_sgpr_count 2
  .amdhsa_user_sgpr_kernarg_segment_ptr 1
  .amdhsa_system_sgpr_workgroup_id_x 1
.end_amdhsa_kernel
```
